```python
import torch

def _softmax(x, axis=-1):
    return torch.softmax(x, dim=axis)
def _gelu(x):
    return torch.nn.functional.gelu(x, approximate="tanh")
def _silu(x):
    return torch.nn.functional.silu(x)
def _sigmoid(x):
    return torch.sigmoid(x)
def _layernorm(x, axis=-1, eps=1e-5):
    m = x.mean(dim=axis, keepdim=True)
    v = x.var(dim=axis, keepdim=True, unbiased=False)
    return (x - m) / torch.sqrt(v + eps)
def _scatter_add(tgt, idx, src, axis=0):
    return tgt.clone().index_add_(axis, idx, src)
def _segment_sum(src, seg, n):
    out = torch.zeros((n,) + src.shape[1:], dtype=src.dtype)
    return out.index_add_(0, seg, src)
def _pad(x, pw):
    flat = tuple(v for pair in reversed(pw) for v in pair)
    return torch.nn.functional.pad(x, flat)

kernel_name = 'standalone__linear_attn_elu__prompt'

def setup_inputs():

    _w = (lambda a: (lambda t: t.to(torch.bfloat16) if t.is_floating_point() else t)(torch.as_tensor(a)))
    B, H, S, D = 1, 32, 2048, 128
    return {
        "q": _w((lambda *s: torch.randn(*s, dtype=torch.bfloat16) * 0.05)(B, H, S, D)),
        "k": _w((lambda *s: torch.randn(*s, dtype=torch.bfloat16) * 0.05)(B, H, S, D)),
        "v": _w((lambda *s: torch.randn(*s, dtype=torch.bfloat16) * 0.05)(B, H, S, D)),
    }

def reference(q, k, v):
    phi_q = torch.where(q > 0, q + 1, torch.exp(q)) + 1e-6
    phi_k = torch.where(k > 0, k + 1, torch.exp(k)) + 1e-6
    kv = torch.einsum("bhsd,bhse->bhde", phi_k, v)
    z = torch.einsum("bhsd->bhd", phi_k)
    num = torch.einsum("bhqd,bhde->bhqe", phi_q, kv)
    den = torch.einsum("bhqd,bhd->bhq", phi_q, z)[..., None] + 1e-6
    return num / den
```

```asm
; @launch grid=(256,1,1) block=(512,1,1) lds=163840
.amdgcn_target "amdgcn-amd-amdhsa--gfx950"
.text
.globl standalone__linear_attn_elu__prompt_kernel
.p2align 8
.type standalone__linear_attn_elu__prompt_kernel,@function
standalone__linear_attn_elu__prompt_kernel:
    s_cmp_ge_u32 s2, 256
    s_cbranch_scc1 L_end
    s_load_dwordx2 s[8:9], s[0:1], 8
    s_load_dwordx2 s[12:13], s[0:1], 16
    s_load_dwordx2 s[28:29], s[0:1], 40
    s_load_dwordx2 s[16:17], s[0:1], 0
    s_load_dwordx2 s[20:21], s[0:1], 24
    s_load_dwordx2 s[24:25], s[0:1], 32
    s_getpc_b64 s[36:37]
    v_lshlrev_b32_e64 v26, 6, v0
    v_min_u32 v26, 0x4268, v26
    global_load_dword v248, v26, s[36:37]
    v_lshrrev_b32 v25, 6, v0
    v_and_b32_e64 v1, 63, v0
    v_readfirstlane_b32 s32, v25
    s_and_b32 s36, s2, 7
    s_lshr_b32 s37, s2, 3
    s_lshl_b32 s36, s36, 5
    s_add_u32 s3, s36, s37
    s_mov_b32 s10, 0x1000000
    s_mov_b32 s11, 0x20000
    s_mov_b32 s14, 0x1000000
    s_mov_b32 s15, 0x20000
    v_lshrrev_b32 v25, 3, v1
    v_and_b32 v26, 6, v25
    v_and_b32 v27, 7, v1
    v_xor_b32 v26, v26, v27
    v_lshlrev_b32_e64 v26, 4, v26
    v_lshl_add_u32 v2, v25, 8, v26
    s_lshr_b32 s37, s3, 2
    s_lshl_b32 s37, s37, 18
    s_lshl_b32 s35, s32, 11
    s_add_u32 s37, s37, s35
    s_and_b32 s36, s3, 1
    s_lshl_b32 s36, s36, 7
    s_add_u32 s36, s36, s37
    v_add_u32 v3, s36, v2
    s_and_b32 s36, s3, 2
    s_lshl_b32 s36, s36, 6
    s_add_u32 s36, s36, s37
    v_add_u32 v2, s36, v2
    s_lshl_b32 s35, s32, 10
    s_mov_b32 s45, 16384
    s_mov_b32 s46, 32768
    s_mov_b32 s47, 49152
    s_waitcnt lgkmcnt(0)
    s_add_u32 m0, s35, 0
    s_nop 0
    buffer_load_dwordx4 v2, s[8:11], 0 offen nt lds
    s_barrier
    s_add_u32 m0, s35, 8192
    s_nop 0
    buffer_load_dwordx4 v2, s[8:11], s45 offen nt lds
    s_barrier
    s_add_u32 m0, s35, 16384
    s_nop 0
    buffer_load_dwordx4 v2, s[8:11], s46 offen nt lds
    s_add_u32 m0, s35, 65536
    s_nop 0
    buffer_load_dwordx4 v3, s[12:15], 0 offen nt lds
    s_lshr_b32 s33, s3, 3
    s_and_b32 s34, s3, 7
    s_mov_b32 s30, 0x800000
    s_mov_b32 s31, 0x20000
    s_mov_b32 s18, 0x1000000
    s_mov_b32 s19, 0x20000
    s_mov_b32 s22, 0x1000000
    s_mov_b32 s23, 0x20000
    s_mov_b32 s26, 0x100
    s_mov_b32 s27, 0x20000
    s_lshl_b32 s43, s3, 13
    s_add_u32 s43, s43, s35
    s_lshl_b32 s4, s3, 8
    s_add_u32 s4, s4, 0x200000
    v_lshlrev_b32 v9, 4, v1
    s_and_b32 s36, s32, 2
    s_lshl_b32 s36, s36, 6
    s_and_b32 s37, s32, 1
    s_lshl_b32 s37, s37, 4
    s_add_u32 s36, s36, s37
    s_add_u32 s4, s4, s36
    v_lshrrev_b32 v18, 4, v1
    v_lshlrev_b32_e64 v18, 5, v18
    v_mov_b32 v25, 0x2000000
    s_cmp_lt_u32 s32, 4
    s_cselect_b32 vcc_lo, 0x10001, 0
    s_cselect_b32 vcc_hi, 0, 0x10001
    v_cndmask_b32 v18, v25, v18, vcc
    v_mov_b32 v132, -1
    v_mov_b32 v133, -1
    v_mov_b32 v134, -1
    v_mov_b32_e64 v135, -1
    s_getreg_b32 s0, hwreg(HW_REG_XCC_ID, 0, 4)
    s_or_b32 s0, s0, 0x80
    v_mov_b32_e64 v131, s0
    s_mul_i32 s0, s0, 0x01010101
    s_mov_b32 s1, s0
    v_cmp_eq_u32 vcc, 0, v0
    v_mov_b32 v122, s3
    v_mov_b32 v123, 0
    v_cndmask_b32 v122, v25, v122, vcc
    s_lshl_b32 s7, s33, 3
    s_mov_b32 s48, 65536
    s_mov_b32 s49, 81920
    s_mov_b32 s50, 98304
    s_mov_b32 s51, 114688
    s_mov_b32 s52, 131072
    s_mov_b32 s53, 147456
    s_mov_b32 s54, 163840
    s_mov_b32 s55, 180224
    s_mov_b32 s56, 196608
    s_mov_b32 s57, 212992
    s_mov_b32 s58, 229376
    s_mov_b32 s59, 245760
    s_lshl_b32 s68, s3, 16
    s_lshl_b32 s37, s32, 13
    s_add_u32 s68, s68, s37
    s_add_u32 s69, s68, 4096
    s_cmp_lt_u32 s32, 4
    s_cselect_b32 s36, 131072, 0
    s_and_b32 s37, s37, 0x7fff
    s_add_u32 s42, s37, s36
    s_mov_b32 s40, 0x3fb8aa3b
    s_mov_b32 s41, s40
    s_mov_b32 s38, 0x358637bd
    s_mov_b32 s39, 0xffff0000
    s_mov_b32 s6, 0
    v_mov_b32 v28, 0x3f803f80
    v_mov_b32 v29, 0x3f803f80
    v_mov_b32 v30, 0x3f803f80
    v_mov_b32 v31, 0x3f803f80
    v_lshrrev_b32 v25, 2, v1
    v_and_b32 v26, 6, v25
    v_lshlrev_b32 v25, 7, v25
    s_lshr_b32 s36, s32, 2
    s_lshl_b32 s37, s36, 12
    v_add_u32 v25, s37, v25
    s_and_b32 s37, s32, 2
    s_lshl_b32 s37, s37, 1
    v_and_b32 v27, 3, v1
    v_or_b32 v27, s37, v27
    v_xor_b32 v27, v27, v26
    v_lshl_add_u32 v4, v27, 4, v25
    s_and_b32 s37, s32, 1
    s_lshl_b32 s37, s37, 3
    v_add_u32 v4, s37, v4
    v_and_b32 v27, 1, v1
    v_lshl_add_u32 v25, v27, 3, v25
    v_add_u32 v25, 65536, v25
    v_bfe_u32 v27, v1, 1, 1
    v_xor_b32 v26, v26, v27
    s_lshl_b32 s37, s36, 2
    s_lshr_b32 s36, s34, 1
    s_and_b32 s36, s36, 2
    s_or_b32 s37, s37, s36
    v_xor_b32 v26, s37, v26
    v_xor_b32 v27, 0, v26
    v_lshl_add_u32 v5, v27, 4, v25
    v_xor_b32 v27, 2, v26
    v_lshl_add_u32 v6, v27, 4, v25
    v_xor_b32 v27, 4, v26
    v_lshl_add_u32 v7, v27, 4, v25
    v_xor_b32 v27, 6, v26
    v_lshl_add_u32 v8, v27, 4, v25
    v_lshrrev_b32 v25, 4, v1
    s_add_u32 m0, s35, 24576
    s_nop 0
    buffer_load_dwordx4 v2, s[8:11], s47 offen nt lds
    s_add_u32 m0, s35, 73728
    s_nop 0
    buffer_load_dwordx4 v3, s[12:15], s45 offen nt lds
    v_and_b32 v26, 15, v1
    v_xor_b32 v27, v25, v26
    v_lshlrev_b32 v27, 4, v27
    v_lshl_add_u32 v10, v25, 8, v27
    v_xor_b32 v11, 64, v10
    v_xor_b32 v12, 128, v10
    v_xor_b32 v13, 192, v10
    v_lshl_add_u32 v14, v26, 8, v27
    v_add_u32 v14, s42, v14
    v_xor_b32 v15, 64, v14
    v_xor_b32 v16, 128, v14
    v_xor_b32 v17, 192, v14
    v_lshlrev_b32 v24, 10, v25
    v_lshl_add_u32 v24, v26, 3, v24
    v_add_u32 v22, 65536, v9
    v_lshlrev_b32_e64 v23, 4, v25
    v_add_u32 v23, 99328, v23
    v_and_b32 v27, 1, v1
    v_lshlrev_b32 v27, 4, v27
    v_mov_b32 v124, 0x3f80
    v_lshlrev_b32 v27, v27, v124
    v_lshrrev_b32 v26, 1, v26
    v_lshlrev_b32 v125, 1, v25
    v_cmp_eq_u32 vcc, v26, v125
    v_add_u32 v125, 1, v125
    s_nop 0
    v_cndmask_b32 v124, 0, v27, vcc
    v_cmp_eq_u32 vcc, v26, v125
    v_mov_b32_e64 v126, v124
    s_nop 0
    v_cndmask_b32 v125, 0, v27, vcc
    v_cndmask_b32 v127, 0, v27, vcc
    s_and_b32 s36, s32, 2
    s_and_b32 s37, s32, 1
    s_lshl_b32 s60, s33, 3
    s_add_u32 s60, s60, s36
    s_lshl_b32 s5, s60, 1
    s_add_u32 s5, s5, s37
    s_lshl_b32 s5, s5, 7
    s_add_u32 s5, s5, 0x200000
    s_lshl_b32 s60, s60, 2
    s_add_u32 s60, s60, s37
    s_lshl_b32 s60, s60, 11
    s_add_u32 s61, s60, 4096
    s_add_u32 s62, s60, 8192
    s_add_u32 s63, s60, 12288
    s_add_u32 s64, s60, 32768
    s_add_u32 s65, s60, 36864
    s_add_u32 s66, s60, 40960
    s_add_u32 s67, s60, 45056
    v_and_b32 v19, 7, v1
    v_lshlrev_b32 v21, 3, v19
    v_and_b32 v27, 3, v1
    v_mul_u32_u24 v27, 1056, v27
    v_lshlrev_b32_e64 v19, 4, v19
    s_and_b32 s36, s32, 3
    s_lshl_b32 s37, s36, 6
    s_add_u32 s37, s37, 99328
    v_add_u32 v21, s37, v21
    s_mul_i32 s36, s36, 8448
    s_add_u32 s36, s36, 65536
    v_lshl_add_u32 v27, v25, 8, v27
    v_bfe_u32 v26, v1, 2, 2
    v_lshl_add_u32 v27, v26, 4, v27
    v_add_u32 v20, s36, v27
    s_mul_i32 s36, s32, 3072
    s_xor_b32 s37, s32, 4
    s_mul_i32 s37, s37, 3072
    s_add_u32 s36, s36, 32768
    s_add_u32 s37, s37, 32768
    v_add_u32 v129, s36, v9
    v_add_u32 v130, s37, v9
L_ret:
L_ch0:
L_ch1:
L_ch2:
L_ch3:
L_ch4:
L_ch5:
L_ch6:
L_ch7:
    s_mov_b64 exec, -1
    s_waitcnt vmcnt(5)
    s_barrier
    ds_read_b64_tr_b16 v[52:53], v4 offset:0
    ds_read_b64_tr_b16 v[54:55], v4 offset:2048
    buffer_store_dwordx4 v[132:135], v9, s[28:31], s43 offen
    buffer_store_dwordx4 v[132:135], v18, s[28:31], s4 offen
    s_add_u32 m0, s35, 32768
    s_nop 0
    buffer_load_dwordx4 v2, s[8:11], s48 offen nt lds
    s_add_u32 m0, s35, 81920
    s_nop 0
    buffer_load_dwordx4 v3, s[12:15], s46 offen nt lds
    s_waitcnt vmcnt(8) lgkmcnt(0)
    s_barrier
    v_lshlrev_b32 v104, 16, v52
    v_and_b32 v105, s39, v52
    ds_read_b64_tr_b16 v[56:57], v4 offset:8192
    v_lshlrev_b32 v106, 16, v53
    v_and_b32 v107, s39, v53
    ds_read_b64_tr_b16 v[58:59], v4 offset:10240
    v_lshlrev_b32 v108, 16, v54
    v_and_b32 v109, s39, v54
    v_lshlrev_b32 v110, 16, v55
    v_and_b32 v111, s39, v55
    v_pk_mul_f32 v[112:113], v[104:105], s[40:41]
    v_pk_mul_f32 v[114:115], v[106:107], s[40:41]
    v_pk_mul_f32 v[116:117], v[108:109], s[40:41]
    v_pk_mul_f32 v[118:119], v[110:111], s[40:41]
    v_exp_f32 v112, v112 clamp
    v_exp_f32 v113, v113 clamp
    v_exp_f32 v114, v114 clamp
    v_exp_f32 v115, v115 clamp
    v_exp_f32 v116, v116 clamp
    v_exp_f32 v117, v117 clamp
    v_exp_f32 v118, v118 clamp
    v_exp_f32 v119, v119 clamp
    v_max_f32 v104, s38, v104
    v_max_f32 v105, s38, v105
    v_max_f32 v106, s38, v106
    v_max_f32 v107, s38, v107
    v_max_f32 v108, s38, v108
    v_max_f32 v109, s38, v109
    v_max_f32 v110, s38, v110
    v_max_f32 v111, s38, v111
    s_add_u32 m0, s35, 40960
    v_pk_add_f32 v[104:105], v[112:113], v[104:105]
    buffer_load_dwordx4 v2, s[8:11], s49 offen nt lds
    v_pk_add_f32 v[106:107], v[114:115], v[106:107]
    s_add_u32 m0, s35, 90112
    v_pk_add_f32 v[108:109], v[116:117], v[108:109]
    buffer_load_dwordx4 v3, s[12:15], s47 offen nt lds
    v_pk_add_f32 v[110:111], v[118:119], v[110:111]
    v_cvt_pk_bf16_f32 v60, v104, v105
    s_waitcnt vmcnt(8) lgkmcnt(0)
    v_cvt_pk_bf16_f32 v61, v106, v107
    v_cvt_pk_bf16_f32 v62, v108, v109
    v_cvt_pk_bf16_f32 v63, v110, v111
    s_barrier
    v_lshlrev_b32 v104, 16, v56
    v_and_b32 v105, s39, v56
    ds_read_b64_tr_b16 v[72:73], v5 offset:0
    v_lshlrev_b32 v106, 16, v57
    v_and_b32 v107, s39, v57
    ds_read_b64_tr_b16 v[74:75], v5 offset:2048
    v_lshlrev_b32 v108, 16, v58
    v_and_b32 v109, s39, v58
    ds_read_b64_tr_b16 v[76:77], v6 offset:0
    v_lshlrev_b32 v110, 16, v59
    v_and_b32 v111, s39, v59
    ds_read_b64_tr_b16 v[78:79], v6 offset:2048
    v_pk_mul_f32 v[112:113], v[104:105], s[40:41]
    v_pk_mul_f32 v[114:115], v[106:107], s[40:41]
    ds_read_b64_tr_b16 v[80:81], v7 offset:0
    v_pk_mul_f32 v[116:117], v[108:109], s[40:41]
    v_pk_mul_f32 v[118:119], v[110:111], s[40:41]
    ds_read_b64_tr_b16 v[82:83], v7 offset:2048
    v_exp_f32 v112, v112 clamp
    v_exp_f32 v113, v113 clamp
    ds_read_b64_tr_b16 v[84:85], v8 offset:0
    v_exp_f32 v114, v114 clamp
    v_exp_f32 v115, v115 clamp
    ds_read_b64_tr_b16 v[86:87], v8 offset:2048
    v_exp_f32 v116, v116 clamp
    v_exp_f32 v117, v117 clamp
    ds_read_b64_tr_b16 v[52:53], v4 offset:16384
    v_exp_f32 v118, v118 clamp
    v_exp_f32 v119, v119 clamp
    ds_read_b64_tr_b16 v[54:55], v4 offset:18432
    v_max_f32 v104, s38, v104
    v_max_f32 v105, s38, v105
    v_max_f32 v106, s38, v106
    v_max_f32 v107, s38, v107
    v_max_f32 v108, s38, v108
    v_max_f32 v109, s38, v109
    v_max_f32 v110, s38, v110
    v_max_f32 v111, s38, v111
    s_add_u32 m0, s35, 49152
    v_pk_add_f32 v[104:105], v[112:113], v[104:105]
    buffer_load_dwordx4 v2, s[8:11], s50 offen nt lds
    v_pk_add_f32 v[106:107], v[114:115], v[106:107]
    s_add_u32 m0, s35, 98304
    v_pk_add_f32 v[108:109], v[116:117], v[108:109]
    buffer_load_dwordx4 v3, s[12:15], s48 offen nt lds
    v_pk_add_f32 v[110:111], v[118:119], v[110:111]
    v_cvt_pk_bf16_f32 v64, v104, v105
    s_waitcnt vmcnt(8) lgkmcnt(0)
    v_cvt_pk_bf16_f32 v65, v106, v107
    v_cvt_pk_bf16_f32 v66, v108, v109
    v_cvt_pk_bf16_f32 v67, v110, v111
    s_barrier
    v_lshlrev_b32 v104, 16, v52
    v_and_b32 v105, s39, v52
    ds_read_b64_tr_b16 v[88:89], v5 offset:8192
    v_lshlrev_b32 v106, 16, v53
    v_and_b32 v107, s39, v53
    ds_read_b64_tr_b16 v[90:91], v5 offset:10240
    v_lshlrev_b32 v108, 16, v54
    v_and_b32 v109, s39, v54
    ds_read_b64_tr_b16 v[92:93], v6 offset:8192
    v_lshlrev_b32 v110, 16, v55
    v_and_b32 v111, s39, v55
    ds_read_b64_tr_b16 v[94:95], v6 offset:10240
    v_pk_mul_f32 v[112:113], v[104:105], s[40:41]
    v_pk_mul_f32 v[114:115], v[106:107], s[40:41]
    ds_read_b64_tr_b16 v[96:97], v7 offset:8192
    v_pk_mul_f32 v[116:117], v[108:109], s[40:41]
    v_pk_mul_f32 v[118:119], v[110:111], s[40:41]
    ds_read_b64_tr_b16 v[98:99], v7 offset:10240
    v_mfma_f32_16x16x32_bf16 v[48:51], v[60:63], v[28:31], 0
    v_exp_f32 v112, v112 clamp
    ds_read_b64_tr_b16 v[100:101], v8 offset:8192
    v_mfma_f32_16x16x32_bf16 v[32:35], v[60:63], v[72:75], 0
    v_exp_f32 v113, v113 clamp
    ds_read_b64_tr_b16 v[102:103], v8 offset:10240
    v_mfma_f32_16x16x32_bf16 v[36:39], v[60:63], v[76:79], 0
    v_exp_f32 v114, v114 clamp
    ds_read_b64_tr_b16 v[56:57], v4 offset:24576
    v_mfma_f32_16x16x32_bf16 v[40:43], v[60:63], v[80:83], 0
    v_exp_f32 v115, v115 clamp
    ds_read_b64_tr_b16 v[58:59], v4 offset:26624
    v_mfma_f32_16x16x32_bf16 v[44:47], v[60:63], v[84:87], 0
    v_exp_f32 v116, v116 clamp
    v_exp_f32 v117, v117 clamp
    v_exp_f32 v118, v118 clamp
    v_exp_f32 v119, v119 clamp
    v_max_f32 v104, s38, v104
    v_max_f32 v105, s38, v105
    v_max_f32 v106, s38, v106
    v_max_f32 v107, s38, v107
    v_max_f32 v108, s38, v108
    v_max_f32 v109, s38, v109
    v_max_f32 v110, s38, v110
    v_max_f32 v111, s38, v111
    s_add_u32 m0, s35, 57344
    v_pk_add_f32 v[104:105], v[112:113], v[104:105]
    buffer_load_dwordx4 v2, s[8:11], s51 offen nt lds
    v_pk_add_f32 v[106:107], v[114:115], v[106:107]
    s_add_u32 m0, s35, 106496
    v_pk_add_f32 v[108:109], v[116:117], v[108:109]
    buffer_load_dwordx4 v3, s[12:15], s49 offen nt lds
    v_pk_add_f32 v[110:111], v[118:119], v[110:111]
    v_cvt_pk_bf16_f32 v68, v104, v105
    s_waitcnt vmcnt(6) lgkmcnt(0)
    v_cvt_pk_bf16_f32 v69, v106, v107
    v_cvt_pk_bf16_f32 v70, v108, v109
    v_cvt_pk_bf16_f32 v71, v110, v111
    s_barrier
    v_lshlrev_b32 v104, 16, v56
    v_and_b32 v105, s39, v56
    ds_read_b64_tr_b16 v[72:73], v5 offset:16384
    v_lshlrev_b32 v106, 16, v57
    v_and_b32 v107, s39, v57
    ds_read_b64_tr_b16 v[74:75], v5 offset:18432
    v_lshlrev_b32 v108, 16, v58
    v_and_b32 v109, s39, v58
    ds_read_b64_tr_b16 v[76:77], v6 offset:16384
    v_lshlrev_b32 v110, 16, v59
    v_and_b32 v111, s39, v59
    ds_read_b64_tr_b16 v[78:79], v6 offset:18432
    v_pk_mul_f32 v[112:113], v[104:105], s[40:41]
    v_pk_mul_f32 v[114:115], v[106:107], s[40:41]
    ds_read_b64_tr_b16 v[80:81], v7 offset:16384
    v_pk_mul_f32 v[116:117], v[108:109], s[40:41]
    v_pk_mul_f32 v[118:119], v[110:111], s[40:41]
    ds_read_b64_tr_b16 v[82:83], v7 offset:18432
    v_mfma_f32_16x16x32_bf16 v[48:51], v[64:67], v[28:31], v[48:51]
    v_exp_f32 v112, v112 clamp
    ds_read_b64_tr_b16 v[84:85], v8 offset:16384
    v_mfma_f32_16x16x32_bf16 v[32:35], v[64:67], v[88:91], v[32:35]
    v_exp_f32 v113, v113 clamp
    ds_read_b64_tr_b16 v[86:87], v8 offset:18432
    v_mfma_f32_16x16x32_bf16 v[36:39], v[64:67], v[92:95], v[36:39]
    v_exp_f32 v114, v114 clamp
    ds_read_b64_tr_b16 v[52:53], v4 offset:32768
    v_mfma_f32_16x16x32_bf16 v[40:43], v[64:67], v[96:99], v[40:43]
    v_exp_f32 v115, v115 clamp
    ds_read_b64_tr_b16 v[54:55], v4 offset:34816
    v_mfma_f32_16x16x32_bf16 v[44:47], v[64:67], v[100:103], v[44:47]
    v_exp_f32 v116, v116 clamp
    v_exp_f32 v117, v117 clamp
    v_exp_f32 v118, v118 clamp
    v_exp_f32 v119, v119 clamp
    v_max_f32 v104, s38, v104
    v_max_f32 v105, s38, v105
    v_max_f32 v106, s38, v106
    v_max_f32 v107, s38, v107
    v_max_f32 v108, s38, v108
    v_max_f32 v109, s38, v109
    v_max_f32 v110, s38, v110
    s_add_u32 m0, s35, 0
    v_max_f32_e64 v111, s38, v111
    buffer_load_dwordx4 v2, s[8:11], s52 offen nt lds
    v_pk_add_f32 v[104:105], v[112:113], v[104:105]
    s_add_u32 m0, s35, 114688
    v_pk_add_f32 v[106:107], v[114:115], v[106:107]
    buffer_load_dwordx4 v3, s[12:15], s50 offen nt lds
    v_pk_add_f32 v[108:109], v[116:117], v[108:109]
    buffer_store_byte v131, v122, s[24:27], 0 offen
    v_pk_add_f32 v[110:111], v[118:119], v[110:111]
    v_cvt_pk_bf16_f32 v60, v104, v105
    s_waitcnt vmcnt(7) lgkmcnt(0)
    v_cvt_pk_bf16_f32 v61, v106, v107
    v_cvt_pk_bf16_f32 v62, v108, v109
    v_cvt_pk_bf16_f32 v63, v110, v111
    s_barrier
    v_lshlrev_b32 v104, 16, v52
    v_and_b32 v105, s39, v52
    ds_read_b64_tr_b16 v[88:89], v5 offset:24576
    v_lshlrev_b32 v106, 16, v53
    v_and_b32 v107, s39, v53
    ds_read_b64_tr_b16 v[90:91], v5 offset:26624
    v_lshlrev_b32 v108, 16, v54
    v_and_b32 v109, s39, v54
    ds_read_b64_tr_b16 v[92:93], v6 offset:24576
    v_lshlrev_b32 v110, 16, v55
    v_and_b32 v111, s39, v55
    ds_read_b64_tr_b16 v[94:95], v6 offset:26624
    v_pk_mul_f32 v[112:113], v[104:105], s[40:41]
    v_pk_mul_f32 v[114:115], v[106:107], s[40:41]
    ds_read_b64_tr_b16 v[96:97], v7 offset:24576
    v_pk_mul_f32 v[116:117], v[108:109], s[40:41]
    v_pk_mul_f32 v[118:119], v[110:111], s[40:41]
    ds_read_b64_tr_b16 v[98:99], v7 offset:26624
    v_mfma_f32_16x16x32_bf16 v[48:51], v[68:71], v[28:31], v[48:51]
    v_exp_f32 v112, v112 clamp
    ds_read_b64_tr_b16 v[100:101], v8 offset:24576
    v_mfma_f32_16x16x32_bf16 v[32:35], v[68:71], v[72:75], v[32:35]
    v_exp_f32 v113, v113 clamp
    ds_read_b64_tr_b16 v[102:103], v8 offset:26624
    v_mfma_f32_16x16x32_bf16 v[36:39], v[68:71], v[76:79], v[36:39]
    v_exp_f32 v114, v114 clamp
    ds_read_b64_tr_b16 v[56:57], v4 offset:40960
    v_mfma_f32_16x16x32_bf16 v[40:43], v[68:71], v[80:83], v[40:43]
    v_exp_f32 v115, v115 clamp
    ds_read_b64_tr_b16 v[58:59], v4 offset:43008
    v_mfma_f32_16x16x32_bf16 v[44:47], v[68:71], v[84:87], v[44:47]
    v_exp_f32 v116, v116 clamp
    v_exp_f32 v117, v117 clamp
    v_exp_f32 v118, v118 clamp
    v_exp_f32 v119, v119 clamp
    v_max_f32 v104, s38, v104
    v_max_f32 v105, s38, v105
    v_max_f32 v106, s38, v106
    v_max_f32 v107, s38, v107
    v_max_f32 v108, s38, v108
    v_max_f32 v109, s38, v109
    v_max_f32 v110, s38, v110
    v_max_f32 v111, s38, v111
    s_add_u32 m0, s35, 8192
    v_pk_add_f32 v[104:105], v[112:113], v[104:105]
    buffer_load_dwordx4 v2, s[8:11], s53 offen nt lds
    v_pk_add_f32 v[106:107], v[114:115], v[106:107]
    s_add_u32 m0, s35, 122880
    v_pk_add_f32 v[108:109], v[116:117], v[108:109]
    buffer_load_dwordx4 v3, s[12:15], s51 offen nt lds
    v_pk_add_f32 v[110:111], v[118:119], v[110:111]
    v_cvt_pk_bf16_f32 v64, v104, v105
    s_waitcnt vmcnt(7) lgkmcnt(0)
    v_cvt_pk_bf16_f32 v65, v106, v107
    v_cvt_pk_bf16_f32 v66, v108, v109
    v_cvt_pk_bf16_f32 v67, v110, v111
    s_barrier
    v_lshlrev_b32 v104, 16, v56
    v_and_b32 v105, s39, v56
    ds_read_b64_tr_b16 v[72:73], v5 offset:32768
    v_lshlrev_b32 v106, 16, v57
    v_and_b32 v107, s39, v57
    ds_read_b64_tr_b16 v[74:75], v5 offset:34816
    v_lshlrev_b32 v108, 16, v58
    v_and_b32 v109, s39, v58
    ds_read_b64_tr_b16 v[76:77], v6 offset:32768
    v_lshlrev_b32 v110, 16, v59
    v_and_b32 v111, s39, v59
    ds_read_b64_tr_b16 v[78:79], v6 offset:34816
    v_pk_mul_f32 v[112:113], v[104:105], s[40:41]
    v_pk_mul_f32 v[114:115], v[106:107], s[40:41]
    ds_read_b64_tr_b16 v[80:81], v7 offset:32768
    v_pk_mul_f32 v[116:117], v[108:109], s[40:41]
    v_pk_mul_f32 v[118:119], v[110:111], s[40:41]
    ds_read_b64_tr_b16 v[82:83], v7 offset:34816
    v_mfma_f32_16x16x32_bf16 v[48:51], v[60:63], v[28:31], v[48:51]
    v_exp_f32 v112, v112 clamp
    ds_read_b64_tr_b16 v[84:85], v8 offset:32768
    v_mfma_f32_16x16x32_bf16 v[32:35], v[60:63], v[88:91], v[32:35]
    v_exp_f32 v113, v113 clamp
    ds_read_b64_tr_b16 v[86:87], v8 offset:34816
    v_mfma_f32_16x16x32_bf16 v[36:39], v[60:63], v[92:95], v[36:39]
    v_exp_f32 v114, v114 clamp
    ds_read_b64_tr_b16 v[52:53], v4 offset:49152
    v_mfma_f32_16x16x32_bf16 v[40:43], v[60:63], v[96:99], v[40:43]
    v_exp_f32 v115, v115 clamp
    ds_read_b64_tr_b16 v[54:55], v4 offset:51200
    v_mfma_f32_16x16x32_bf16 v[44:47], v[60:63], v[100:103], v[44:47]
    v_exp_f32 v116, v116 clamp
    v_exp_f32 v117, v117 clamp
    v_exp_f32 v118, v118 clamp
    v_exp_f32 v119, v119 clamp
    v_max_f32 v104, s38, v104
    v_max_f32 v105, s38, v105
    v_max_f32 v106, s38, v106
    v_max_f32 v107, s38, v107
    v_max_f32 v108, s38, v108
    v_max_f32 v109, s38, v109
    v_max_f32 v110, s38, v110
    v_max_f32 v111, s38, v111
    s_add_u32 m0, s35, 16384
    v_pk_add_f32 v[104:105], v[112:113], v[104:105]
    buffer_load_dwordx4 v2, s[8:11], s54 offen nt lds
    v_pk_add_f32 v[106:107], v[114:115], v[106:107]
    s_add_u32 m0, s35, 65536
    v_pk_add_f32 v[108:109], v[116:117], v[108:109]
    buffer_load_dwordx4 v3, s[12:15], s52 offen nt lds
    v_pk_add_f32 v[110:111], v[118:119], v[110:111]
    v_cvt_pk_bf16_f32 v68, v104, v105
    s_waitcnt vmcnt(7) lgkmcnt(0)
    v_cvt_pk_bf16_f32 v69, v106, v107
    v_cvt_pk_bf16_f32 v70, v108, v109
    v_cvt_pk_bf16_f32 v71, v110, v111
    s_barrier
    v_lshlrev_b32 v104, 16, v52
    v_and_b32 v105, s39, v52
    ds_read_b64_tr_b16 v[88:89], v5 offset:40960
    v_lshlrev_b32 v106, 16, v53
    v_and_b32 v107, s39, v53
    ds_read_b64_tr_b16 v[90:91], v5 offset:43008
    v_lshlrev_b32 v108, 16, v54
    v_and_b32 v109, s39, v54
    ds_read_b64_tr_b16 v[92:93], v6 offset:40960
    v_lshlrev_b32 v110, 16, v55
    v_and_b32 v111, s39, v55
    ds_read_b64_tr_b16 v[94:95], v6 offset:43008
    v_pk_mul_f32 v[112:113], v[104:105], s[40:41]
    v_pk_mul_f32 v[114:115], v[106:107], s[40:41]
    ds_read_b64_tr_b16 v[96:97], v7 offset:40960
    v_pk_mul_f32 v[116:117], v[108:109], s[40:41]
    v_pk_mul_f32 v[118:119], v[110:111], s[40:41]
    ds_read_b64_tr_b16 v[98:99], v7 offset:43008
    v_mfma_f32_16x16x32_bf16 v[48:51], v[64:67], v[28:31], v[48:51]
    v_exp_f32 v112, v112 clamp
    ds_read_b64_tr_b16 v[100:101], v8 offset:40960
    v_mfma_f32_16x16x32_bf16 v[32:35], v[64:67], v[72:75], v[32:35]
    v_exp_f32 v113, v113 clamp
    ds_read_b64_tr_b16 v[102:103], v8 offset:43008
    v_mfma_f32_16x16x32_bf16 v[36:39], v[64:67], v[76:79], v[36:39]
    v_exp_f32 v114, v114 clamp
    ds_read_b64_tr_b16 v[56:57], v4 offset:57344
    v_mfma_f32_16x16x32_bf16 v[40:43], v[64:67], v[80:83], v[40:43]
    v_exp_f32 v115, v115 clamp
    ds_read_b64_tr_b16 v[58:59], v4 offset:59392
    v_mfma_f32_16x16x32_bf16 v[44:47], v[64:67], v[84:87], v[44:47]
    v_exp_f32 v116, v116 clamp
    v_exp_f32 v117, v117 clamp
    v_exp_f32 v118, v118 clamp
    v_exp_f32 v119, v119 clamp
    v_max_f32 v104, s38, v104
    v_max_f32 v105, s38, v105
    v_max_f32 v106, s38, v106
    v_max_f32 v107, s38, v107
    v_max_f32 v108, s38, v108
    v_max_f32 v109, s38, v109
    v_max_f32 v110, s38, v110
    v_max_f32 v111, s38, v111
    s_add_u32 m0, s35, 24576
    v_pk_add_f32 v[104:105], v[112:113], v[104:105]
    buffer_load_dwordx4 v2, s[8:11], s55 offen nt lds
    v_pk_add_f32 v[106:107], v[114:115], v[106:107]
    s_add_u32 m0, s35, 73728
    v_pk_add_f32 v[108:109], v[116:117], v[108:109]
    buffer_load_dwordx4 v3, s[12:15], s53 offen nt lds
    v_pk_add_f32 v[110:111], v[118:119], v[110:111]
    v_cvt_pk_bf16_f32 v60, v104, v105
    s_waitcnt vmcnt(7) lgkmcnt(0)
    v_cvt_pk_bf16_f32 v61, v106, v107
    v_cvt_pk_bf16_f32 v62, v108, v109
    v_cvt_pk_bf16_f32 v63, v110, v111
    s_barrier
    v_lshlrev_b32 v104, 16, v56
    v_and_b32 v105, s39, v56
    ds_read_b64_tr_b16 v[72:73], v5 offset:49152
    v_lshlrev_b32 v106, 16, v57
    v_and_b32 v107, s39, v57
    ds_read_b64_tr_b16 v[74:75], v5 offset:51200
    v_lshlrev_b32 v108, 16, v58
    v_and_b32 v109, s39, v58
    ds_read_b64_tr_b16 v[76:77], v6 offset:49152
    v_lshlrev_b32 v110, 16, v59
    v_and_b32 v111, s39, v59
    ds_read_b64_tr_b16 v[78:79], v6 offset:51200
    v_pk_mul_f32 v[112:113], v[104:105], s[40:41]
    v_pk_mul_f32 v[114:115], v[106:107], s[40:41]
    ds_read_b64_tr_b16 v[80:81], v7 offset:49152
    v_pk_mul_f32 v[116:117], v[108:109], s[40:41]
    v_pk_mul_f32 v[118:119], v[110:111], s[40:41]
    ds_read_b64_tr_b16 v[82:83], v7 offset:51200
    v_mfma_f32_16x16x32_bf16 v[48:51], v[68:71], v[28:31], v[48:51]
    v_exp_f32 v112, v112 clamp
    ds_read_b64_tr_b16 v[84:85], v8 offset:49152
    v_mfma_f32_16x16x32_bf16 v[32:35], v[68:71], v[88:91], v[32:35]
    v_exp_f32 v113, v113 clamp
    ds_read_b64_tr_b16 v[86:87], v8 offset:51200
    v_mfma_f32_16x16x32_bf16 v[36:39], v[68:71], v[92:95], v[36:39]
    v_exp_f32 v114, v114 clamp
    ds_read_b64_tr_b16 v[52:53], v4 offset:0
    v_mfma_f32_16x16x32_bf16 v[40:43], v[68:71], v[96:99], v[40:43]
    v_exp_f32 v115, v115 clamp
    ds_read_b64_tr_b16 v[54:55], v4 offset:2048
    v_mfma_f32_16x16x32_bf16 v[44:47], v[68:71], v[100:103], v[44:47]
    v_exp_f32 v116, v116 clamp
    v_exp_f32 v117, v117 clamp
    v_exp_f32 v118, v118 clamp
    v_exp_f32 v119, v119 clamp
    v_max_f32 v104, s38, v104
    v_max_f32 v105, s38, v105
    v_max_f32 v106, s38, v106
    v_max_f32 v107, s38, v107
    v_max_f32 v108, s38, v108
    v_max_f32 v109, s38, v109
    v_max_f32 v110, s38, v110
    v_max_f32 v111, s38, v111
    s_add_u32 m0, s35, 32768
    v_pk_add_f32 v[104:105], v[112:113], v[104:105]
    buffer_load_dwordx4 v2, s[8:11], s56 offen nt lds
    v_pk_add_f32 v[106:107], v[114:115], v[106:107]
    s_add_u32 m0, s35, 81920
    v_pk_add_f32 v[108:109], v[116:117], v[108:109]
    buffer_load_dwordx4 v3, s[12:15], s54 offen nt lds
    v_pk_add_f32 v[110:111], v[118:119], v[110:111]
    v_cvt_pk_bf16_f32 v64, v104, v105
    s_waitcnt vmcnt(6) lgkmcnt(0)
    v_cvt_pk_bf16_f32 v65, v106, v107
    v_cvt_pk_bf16_f32 v66, v108, v109
    v_cvt_pk_bf16_f32 v67, v110, v111
    s_barrier
    v_lshlrev_b32 v104, 16, v52
    v_and_b32 v105, s39, v52
    ds_read_b64_tr_b16 v[88:89], v5 offset:57344
    v_lshlrev_b32 v106, 16, v53
    v_and_b32 v107, s39, v53
    ds_read_b64_tr_b16 v[90:91], v5 offset:59392
    v_lshlrev_b32 v108, 16, v54
    v_and_b32 v109, s39, v54
    ds_read_b64_tr_b16 v[92:93], v6 offset:57344
    v_lshlrev_b32 v110, 16, v55
    v_and_b32 v111, s39, v55
    ds_read_b64_tr_b16 v[94:95], v6 offset:59392
    v_pk_mul_f32 v[112:113], v[104:105], s[40:41]
    v_pk_mul_f32 v[114:115], v[106:107], s[40:41]
    ds_read_b64_tr_b16 v[96:97], v7 offset:57344
    v_pk_mul_f32 v[116:117], v[108:109], s[40:41]
    v_pk_mul_f32 v[118:119], v[110:111], s[40:41]
    ds_read_b64_tr_b16 v[98:99], v7 offset:59392
    v_mfma_f32_16x16x32_bf16 v[48:51], v[60:63], v[28:31], v[48:51]
    v_exp_f32 v112, v112 clamp
    ds_read_b64_tr_b16 v[100:101], v8 offset:57344
    v_mfma_f32_16x16x32_bf16 v[32:35], v[60:63], v[72:75], v[32:35]
    v_exp_f32 v113, v113 clamp
    ds_read_b64_tr_b16 v[102:103], v8 offset:59392
    v_mfma_f32_16x16x32_bf16 v[36:39], v[60:63], v[76:79], v[36:39]
    v_exp_f32 v114, v114 clamp
    ds_read_b64_tr_b16 v[56:57], v4 offset:8192
    v_mfma_f32_16x16x32_bf16 v[40:43], v[60:63], v[80:83], v[40:43]
    v_exp_f32 v115, v115 clamp
    ds_read_b64_tr_b16 v[58:59], v4 offset:10240
    v_mfma_f32_16x16x32_bf16 v[44:47], v[60:63], v[84:87], v[44:47]
    v_exp_f32 v116, v116 clamp
    v_exp_f32 v117, v117 clamp
    v_exp_f32 v118, v118 clamp
    v_exp_f32 v119, v119 clamp
    v_max_f32 v104, s38, v104
    v_max_f32 v105, s38, v105
    v_max_f32 v106, s38, v106
    v_max_f32 v107, s38, v107
    v_max_f32 v108, s38, v108
    v_max_f32 v109, s38, v109
    v_max_f32 v110, s38, v110
    v_max_f32 v111, s38, v111
    s_add_u32 m0, s35, 40960
    v_pk_add_f32 v[104:105], v[112:113], v[104:105]
    buffer_load_dwordx4 v2, s[8:11], s57 offen nt lds
    v_pk_add_f32 v[106:107], v[114:115], v[106:107]
    s_add_u32 m0, s35, 90112
    v_pk_add_f32 v[108:109], v[116:117], v[108:109]
    buffer_load_dwordx4 v3, s[12:15], s55 offen nt lds
    v_pk_add_f32 v[110:111], v[118:119], v[110:111]
    v_cvt_pk_bf16_f32 v68, v104, v105
    s_waitcnt vmcnt(6) lgkmcnt(0)
    v_cvt_pk_bf16_f32 v69, v106, v107
    v_cvt_pk_bf16_f32 v70, v108, v109
    v_cvt_pk_bf16_f32 v71, v110, v111
    s_barrier
    v_lshlrev_b32 v104, 16, v56
    v_and_b32 v105, s39, v56
    ds_read_b64_tr_b16 v[72:73], v5 offset:0
    v_lshlrev_b32 v106, 16, v57
    v_and_b32 v107, s39, v57
    ds_read_b64_tr_b16 v[74:75], v5 offset:2048
    v_lshlrev_b32 v108, 16, v58
    v_and_b32 v109, s39, v58
    ds_read_b64_tr_b16 v[76:77], v6 offset:0
    v_lshlrev_b32 v110, 16, v59
    v_and_b32 v111, s39, v59
    ds_read_b64_tr_b16 v[78:79], v6 offset:2048
    v_pk_mul_f32 v[112:113], v[104:105], s[40:41]
    v_pk_mul_f32 v[114:115], v[106:107], s[40:41]
    ds_read_b64_tr_b16 v[80:81], v7 offset:0
    v_pk_mul_f32 v[116:117], v[108:109], s[40:41]
    v_pk_mul_f32 v[118:119], v[110:111], s[40:41]
    ds_read_b64_tr_b16 v[82:83], v7 offset:2048
    v_mfma_f32_16x16x32_bf16 v[48:51], v[64:67], v[28:31], v[48:51]
    v_exp_f32 v112, v112 clamp
    ds_read_b64_tr_b16 v[84:85], v8 offset:0
    v_mfma_f32_16x16x32_bf16 v[32:35], v[64:67], v[88:91], v[32:35]
    v_exp_f32 v113, v113 clamp
    ds_read_b64_tr_b16 v[86:87], v8 offset:2048
    v_mfma_f32_16x16x32_bf16 v[36:39], v[64:67], v[92:95], v[36:39]
    v_exp_f32 v114, v114 clamp
    ds_read_b64_tr_b16 v[52:53], v4 offset:16384
    v_mfma_f32_16x16x32_bf16 v[40:43], v[64:67], v[96:99], v[40:43]
    v_exp_f32 v115, v115 clamp
    ds_read_b64_tr_b16 v[54:55], v4 offset:18432
    v_mfma_f32_16x16x32_bf16 v[44:47], v[64:67], v[100:103], v[44:47]
    v_exp_f32 v116, v116 clamp
    v_exp_f32 v117, v117 clamp
    v_exp_f32 v118, v118 clamp
    v_exp_f32 v119, v119 clamp
    v_max_f32 v104, s38, v104
    v_max_f32 v105, s38, v105
    v_max_f32 v106, s38, v106
    v_max_f32 v107, s38, v107
    v_max_f32 v108, s38, v108
    v_max_f32 v109, s38, v109
    v_max_f32 v110, s38, v110
    v_max_f32 v111, s38, v111
    s_add_u32 m0, s35, 49152
    v_pk_add_f32 v[104:105], v[112:113], v[104:105]
    buffer_load_dwordx4 v2, s[8:11], s58 offen nt lds
    v_pk_add_f32 v[106:107], v[114:115], v[106:107]
    s_add_u32 m0, s35, 98304
    v_pk_add_f32 v[108:109], v[116:117], v[108:109]
    buffer_load_dwordx4 v3, s[12:15], s56 offen nt lds
    v_pk_add_f32 v[110:111], v[118:119], v[110:111]
    v_cvt_pk_bf16_f32 v60, v104, v105
    s_waitcnt vmcnt(6) lgkmcnt(0)
    v_cvt_pk_bf16_f32 v61, v106, v107
    v_cvt_pk_bf16_f32 v62, v108, v109
    v_cvt_pk_bf16_f32 v63, v110, v111
    s_barrier
    v_lshlrev_b32 v104, 16, v52
    v_and_b32 v105, s39, v52
    ds_read_b64_tr_b16 v[88:89], v5 offset:8192
    v_lshlrev_b32 v106, 16, v53
    v_and_b32 v107, s39, v53
    ds_read_b64_tr_b16 v[90:91], v5 offset:10240
    v_lshlrev_b32 v108, 16, v54
    v_and_b32 v109, s39, v54
    ds_read_b64_tr_b16 v[92:93], v6 offset:8192
    v_lshlrev_b32 v110, 16, v55
    v_and_b32 v111, s39, v55
    ds_read_b64_tr_b16 v[94:95], v6 offset:10240
    v_pk_mul_f32 v[112:113], v[104:105], s[40:41]
    v_pk_mul_f32 v[114:115], v[106:107], s[40:41]
    ds_read_b64_tr_b16 v[96:97], v7 offset:8192
    v_pk_mul_f32 v[116:117], v[108:109], s[40:41]
    v_pk_mul_f32 v[118:119], v[110:111], s[40:41]
    ds_read_b64_tr_b16 v[98:99], v7 offset:10240
    v_mfma_f32_16x16x32_bf16 v[48:51], v[68:71], v[28:31], v[48:51]
    v_exp_f32 v112, v112 clamp
    ds_read_b64_tr_b16 v[100:101], v8 offset:8192
    v_mfma_f32_16x16x32_bf16 v[32:35], v[68:71], v[72:75], v[32:35]
    v_exp_f32 v113, v113 clamp
    ds_read_b64_tr_b16 v[102:103], v8 offset:10240
    v_mfma_f32_16x16x32_bf16 v[36:39], v[68:71], v[76:79], v[36:39]
    v_exp_f32 v114, v114 clamp
    ds_read_b64_tr_b16 v[56:57], v4 offset:24576
    v_mfma_f32_16x16x32_bf16 v[40:43], v[68:71], v[80:83], v[40:43]
    v_exp_f32 v115, v115 clamp
    ds_read_b64_tr_b16 v[58:59], v4 offset:26624
    v_mfma_f32_16x16x32_bf16 v[44:47], v[68:71], v[84:87], v[44:47]
    v_exp_f32 v116, v116 clamp
    v_exp_f32 v117, v117 clamp
    v_exp_f32 v118, v118 clamp
    v_exp_f32 v119, v119 clamp
    v_max_f32 v104, s38, v104
    v_max_f32 v105, s38, v105
    v_max_f32 v106, s38, v106
    v_max_f32 v107, s38, v107
    v_max_f32 v108, s38, v108
    v_max_f32 v109, s38, v109
    v_max_f32 v110, s38, v110
    v_max_f32 v111, s38, v111
    s_add_u32 m0, s35, 57344
    v_pk_add_f32 v[104:105], v[112:113], v[104:105]
    buffer_load_dwordx4 v2, s[8:11], s59 offen nt lds
    v_pk_add_f32 v[106:107], v[114:115], v[106:107]
    s_add_u32 m0, s35, 106496
    v_pk_add_f32 v[108:109], v[116:117], v[108:109]
    buffer_load_dwordx4 v3, s[12:15], s57 offen nt lds
    v_pk_add_f32 v[110:111], v[118:119], v[110:111]
    v_cvt_pk_bf16_f32 v64, v104, v105
    s_waitcnt vmcnt(6) lgkmcnt(0)
    v_cvt_pk_bf16_f32 v65, v106, v107
    v_cvt_pk_bf16_f32 v66, v108, v109
    v_cvt_pk_bf16_f32 v67, v110, v111
    s_cmp_lt_u32 s32, 4
    s_cbranch_scc1 L_E
    s_barrier
    v_lshlrev_b32 v104, 16, v56
    v_and_b32 v105, s39, v56
    ds_read_b64_tr_b16 v[72:73], v5 offset:16384
    v_lshlrev_b32 v106, 16, v57
    v_and_b32 v107, s39, v57
    ds_read_b64_tr_b16 v[74:75], v5 offset:18432
    v_lshlrev_b32 v108, 16, v58
    v_and_b32 v109, s39, v58
    ds_read_b64_tr_b16 v[76:77], v6 offset:16384
    v_lshlrev_b32 v110, 16, v59
    v_and_b32 v111, s39, v59
    ds_read_b64_tr_b16 v[78:79], v6 offset:18432
    v_pk_mul_f32 v[112:113], v[104:105], s[40:41]
    v_pk_mul_f32 v[114:115], v[106:107], s[40:41]
    ds_read_b64_tr_b16 v[80:81], v7 offset:16384
    v_pk_mul_f32 v[116:117], v[108:109], s[40:41]
    v_pk_mul_f32 v[118:119], v[110:111], s[40:41]
    ds_read_b64_tr_b16 v[82:83], v7 offset:18432
    v_mfma_f32_16x16x32_bf16 v[48:51], v[60:63], v[28:31], v[48:51]
    v_exp_f32 v112, v112 clamp
    ds_read_b64_tr_b16 v[84:85], v8 offset:16384
    v_mfma_f32_16x16x32_bf16 v[32:35], v[60:63], v[88:91], v[32:35]
    v_exp_f32 v113, v113 clamp
    ds_read_b64_tr_b16 v[86:87], v8 offset:18432
    v_mfma_f32_16x16x32_bf16 v[36:39], v[60:63], v[92:95], v[36:39]
    v_exp_f32 v114, v114 clamp
    ds_read_b64_tr_b16 v[52:53], v4 offset:32768
    v_mfma_f32_16x16x32_bf16 v[40:43], v[60:63], v[96:99], v[40:43]
    v_exp_f32 v115, v115 clamp
    ds_read_b64_tr_b16 v[54:55], v4 offset:34816
    v_mfma_f32_16x16x32_bf16 v[44:47], v[60:63], v[100:103], v[44:47]
    v_exp_f32 v116, v116 clamp
    v_exp_f32 v117, v117 clamp
    v_exp_f32 v118, v118 clamp
    v_exp_f32 v119, v119 clamp
    v_max_f32 v104, s38, v104
    v_max_f32 v105, s38, v105
    v_max_f32 v106, s38, v106
    v_max_f32 v107, s38, v107
    v_max_f32 v108, s38, v108
    v_max_f32 v109, s38, v109
    v_max_f32 v110, s38, v110
    v_max_f32 v111, s38, v111
    v_pk_add_f32 v[104:105], v[112:113], v[104:105]
    v_pk_add_f32 v[106:107], v[114:115], v[106:107]
    s_add_u32 m0, s35, 114688
    v_pk_add_f32 v[108:109], v[116:117], v[108:109]
    buffer_load_dwordx4 v3, s[12:15], s58 offen nt lds
    v_pk_add_f32 v[110:111], v[118:119], v[110:111]
    v_cvt_pk_bf16_f32 v68, v104, v105
    s_waitcnt vmcnt(5) lgkmcnt(0)
    v_cvt_pk_bf16_f32 v69, v106, v107
    v_cvt_pk_bf16_f32 v70, v108, v109
    v_cvt_pk_bf16_f32 v71, v110, v111
    s_barrier
    v_lshlrev_b32 v104, 16, v52
    v_and_b32 v105, s39, v52
    ds_read_b64_tr_b16 v[88:89], v5 offset:24576
    v_lshlrev_b32 v106, 16, v53
    v_and_b32 v107, s39, v53
    ds_read_b64_tr_b16 v[90:91], v5 offset:26624
    v_lshlrev_b32 v108, 16, v54
    v_and_b32 v109, s39, v54
    ds_read_b64_tr_b16 v[92:93], v6 offset:24576
    v_lshlrev_b32 v110, 16, v55
    v_and_b32 v111, s39, v55
    ds_read_b64_tr_b16 v[94:95], v6 offset:26624
    v_pk_mul_f32 v[112:113], v[104:105], s[40:41]
    v_pk_mul_f32 v[114:115], v[106:107], s[40:41]
    ds_read_b64_tr_b16 v[96:97], v7 offset:24576
    v_pk_mul_f32 v[116:117], v[108:109], s[40:41]
    v_pk_mul_f32 v[118:119], v[110:111], s[40:41]
    ds_read_b64_tr_b16 v[98:99], v7 offset:26624
    v_mfma_f32_16x16x32_bf16 v[48:51], v[64:67], v[28:31], v[48:51]
    v_exp_f32 v112, v112 clamp
    ds_read_b64_tr_b16 v[100:101], v8 offset:24576
    v_mfma_f32_16x16x32_bf16 v[32:35], v[64:67], v[72:75], v[32:35]
    v_exp_f32 v113, v113 clamp
    ds_read_b64_tr_b16 v[102:103], v8 offset:26624
    v_mfma_f32_16x16x32_bf16 v[36:39], v[64:67], v[76:79], v[36:39]
    v_exp_f32 v114, v114 clamp
    ds_read_b64_tr_b16 v[56:57], v4 offset:40960
    v_mfma_f32_16x16x32_bf16 v[40:43], v[64:67], v[80:83], v[40:43]
    v_exp_f32 v115, v115 clamp
    ds_read_b64_tr_b16 v[58:59], v4 offset:43008
    v_mfma_f32_16x16x32_bf16 v[44:47], v[64:67], v[84:87], v[44:47]
    v_exp_f32 v116, v116 clamp
    v_exp_f32 v117, v117 clamp
    v_exp_f32 v118, v118 clamp
    v_exp_f32 v119, v119 clamp
    v_max_f32 v104, s38, v104
    v_max_f32 v105, s38, v105
    v_max_f32 v106, s38, v106
    v_max_f32 v107, s38, v107
    v_max_f32 v108, s38, v108
    v_max_f32 v109, s38, v109
    v_max_f32 v110, s38, v110
    v_max_f32 v111, s38, v111
    v_pk_add_f32 v[104:105], v[112:113], v[104:105]
    s_add_u32 m0, s35, 122880
    v_pk_add_f32 v[106:107], v[114:115], v[106:107]
    buffer_load_dwordx4 v3, s[12:15], s59 offen nt lds
    v_pk_add_f32 v[108:109], v[116:117], v[108:109]
    buffer_load_dwordx2 v[120:121], v123, s[24:27], s7 offen sc1
    v_pk_add_f32 v[110:111], v[118:119], v[110:111]
    v_cvt_pk_bf16_f32 v60, v104, v105
    s_waitcnt vmcnt(5) lgkmcnt(0)
    v_cvt_pk_bf16_f32 v61, v106, v107
    v_cvt_pk_bf16_f32 v62, v108, v109
    v_cvt_pk_bf16_f32 v63, v110, v111
    s_barrier
    v_lshlrev_b32 v104, 16, v56
    v_and_b32 v105, s39, v56
    ds_read_b64_tr_b16 v[72:73], v5 offset:32768
    v_lshlrev_b32 v106, 16, v57
    v_and_b32 v107, s39, v57
    ds_read_b64_tr_b16 v[74:75], v5 offset:34816
    v_lshlrev_b32 v108, 16, v58
    v_and_b32 v109, s39, v58
    ds_read_b64_tr_b16 v[76:77], v6 offset:32768
    v_lshlrev_b32 v110, 16, v59
    v_and_b32 v111, s39, v59
    ds_read_b64_tr_b16 v[78:79], v6 offset:34816
    v_pk_mul_f32 v[112:113], v[104:105], s[40:41]
    v_pk_mul_f32 v[114:115], v[106:107], s[40:41]
    ds_read_b64_tr_b16 v[80:81], v7 offset:32768
    v_pk_mul_f32 v[116:117], v[108:109], s[40:41]
    v_pk_mul_f32 v[118:119], v[110:111], s[40:41]
    ds_read_b64_tr_b16 v[82:83], v7 offset:34816
    v_mfma_f32_16x16x32_bf16 v[48:51], v[68:71], v[28:31], v[48:51]
    v_exp_f32 v112, v112 clamp
    ds_read_b64_tr_b16 v[84:85], v8 offset:32768
    v_mfma_f32_16x16x32_bf16 v[32:35], v[68:71], v[88:91], v[32:35]
    v_exp_f32 v113, v113 clamp
    ds_read_b64_tr_b16 v[86:87], v8 offset:34816
    v_mfma_f32_16x16x32_bf16 v[36:39], v[68:71], v[92:95], v[36:39]
    v_exp_f32 v114, v114 clamp
    ds_read_b64_tr_b16 v[52:53], v4 offset:49152
    v_mfma_f32_16x16x32_bf16 v[40:43], v[68:71], v[96:99], v[40:43]
    v_exp_f32 v115, v115 clamp
    ds_read_b64_tr_b16 v[54:55], v4 offset:51200
    v_mfma_f32_16x16x32_bf16 v[44:47], v[68:71], v[100:103], v[44:47]
    v_exp_f32 v116, v116 clamp
    v_exp_f32 v117, v117 clamp
    v_exp_f32 v118, v118 clamp
    v_exp_f32 v119, v119 clamp
    v_max_f32 v104, s38, v104
    v_max_f32 v105, s38, v105
    v_max_f32 v106, s38, v106
    v_max_f32 v107, s38, v107
    v_max_f32 v108, s38, v108
    v_max_f32 v109, s38, v109
    v_max_f32 v110, s38, v110
    v_max_f32 v111, s38, v111
    v_pk_add_f32 v[104:105], v[112:113], v[104:105]
    v_pk_add_f32 v[106:107], v[114:115], v[106:107]
    v_pk_add_f32 v[108:109], v[116:117], v[108:109]
    v_pk_add_f32 v[110:111], v[118:119], v[110:111]
    v_cvt_pk_bf16_f32 v64, v104, v105
    s_waitcnt vmcnt(3) lgkmcnt(0)
    v_cvt_pk_bf16_f32 v65, v106, v107
    v_cvt_pk_bf16_f32 v66, v108, v109
    v_cvt_pk_bf16_f32 v67, v110, v111
    s_barrier
    v_lshlrev_b32 v104, 16, v52
    v_and_b32 v105, s39, v52
    ds_read_b64_tr_b16 v[88:89], v5 offset:40960
    v_lshlrev_b32 v106, 16, v53
    v_and_b32 v107, s39, v53
    ds_read_b64_tr_b16 v[90:91], v5 offset:43008
    v_lshlrev_b32 v108, 16, v54
    v_and_b32 v109, s39, v54
    ds_read_b64_tr_b16 v[92:93], v6 offset:40960
    v_lshlrev_b32 v110, 16, v55
    v_and_b32 v111, s39, v55
    ds_read_b64_tr_b16 v[94:95], v6 offset:43008
    v_pk_mul_f32 v[112:113], v[104:105], s[40:41]
    v_pk_mul_f32 v[114:115], v[106:107], s[40:41]
    ds_read_b64_tr_b16 v[96:97], v7 offset:40960
    v_pk_mul_f32 v[116:117], v[108:109], s[40:41]
    v_pk_mul_f32 v[118:119], v[110:111], s[40:41]
    ds_read_b64_tr_b16 v[98:99], v7 offset:43008
    v_mfma_f32_16x16x32_bf16 v[48:51], v[60:63], v[28:31], v[48:51]
    v_exp_f32 v112, v112 clamp
    ds_read_b64_tr_b16 v[100:101], v8 offset:40960
    v_mfma_f32_16x16x32_bf16 v[32:35], v[60:63], v[72:75], v[32:35]
    v_exp_f32 v113, v113 clamp
    ds_read_b64_tr_b16 v[102:103], v8 offset:43008
    v_mfma_f32_16x16x32_bf16 v[36:39], v[60:63], v[76:79], v[36:39]
    v_exp_f32 v114, v114 clamp
    ds_read_b64_tr_b16 v[56:57], v4 offset:57344
    v_mfma_f32_16x16x32_bf16 v[40:43], v[60:63], v[80:83], v[40:43]
    v_exp_f32 v115, v115 clamp
    ds_read_b64_tr_b16 v[58:59], v4 offset:59392
    v_mfma_f32_16x16x32_bf16 v[44:47], v[60:63], v[84:87], v[44:47]
    v_exp_f32 v116, v116 clamp
    v_exp_f32 v117, v117 clamp
    v_exp_f32 v118, v118 clamp
    v_exp_f32 v119, v119 clamp
    v_max_f32 v104, s38, v104
    v_max_f32 v105, s38, v105
    v_max_f32 v106, s38, v106
    v_max_f32 v107, s38, v107
    v_max_f32 v108, s38, v108
    v_max_f32 v109, s38, v109
    v_max_f32 v110, s38, v110
    v_max_f32 v111, s38, v111
    v_pk_add_f32 v[104:105], v[112:113], v[104:105]
    v_pk_add_f32 v[106:107], v[114:115], v[106:107]
    v_pk_add_f32 v[108:109], v[116:117], v[108:109]
    v_pk_add_f32 v[110:111], v[118:119], v[110:111]
    v_cvt_pk_bf16_f32 v68, v104, v105
    s_waitcnt vmcnt(2) lgkmcnt(0)
    v_cvt_pk_bf16_f32 v69, v106, v107
    v_cvt_pk_bf16_f32 v70, v108, v109
    v_cvt_pk_bf16_f32 v71, v110, v111
    s_barrier
    v_lshlrev_b32 v104, 16, v56
    v_and_b32 v105, s39, v56
    ds_read_b64_tr_b16 v[72:73], v5 offset:49152
    v_lshlrev_b32 v106, 16, v57
    v_and_b32 v107, s39, v57
    ds_read_b64_tr_b16 v[74:75], v5 offset:51200
    v_lshlrev_b32 v108, 16, v58
    v_and_b32 v109, s39, v58
    ds_read_b64_tr_b16 v[76:77], v6 offset:49152
    v_lshlrev_b32 v110, 16, v59
    v_and_b32 v111, s39, v59
    ds_read_b64_tr_b16 v[78:79], v6 offset:51200
    v_pk_mul_f32 v[112:113], v[104:105], s[40:41]
    v_pk_mul_f32 v[114:115], v[106:107], s[40:41]
    ds_read_b64_tr_b16 v[80:81], v7 offset:49152
    v_pk_mul_f32 v[116:117], v[108:109], s[40:41]
    v_pk_mul_f32 v[118:119], v[110:111], s[40:41]
    ds_read_b64_tr_b16 v[82:83], v7 offset:51200
    v_mfma_f32_16x16x32_bf16 v[48:51], v[64:67], v[28:31], v[48:51]
    v_exp_f32 v112, v112 clamp
    ds_read_b64_tr_b16 v[84:85], v8 offset:49152
    v_mfma_f32_16x16x32_bf16 v[32:35], v[64:67], v[88:91], v[32:35]
    v_exp_f32 v113, v113 clamp
    ds_read_b64_tr_b16 v[86:87], v8 offset:51200
    v_mfma_f32_16x16x32_bf16 v[36:39], v[64:67], v[92:95], v[36:39]
    v_exp_f32 v114, v114 clamp
    v_mfma_f32_16x16x32_bf16 v[40:43], v[64:67], v[96:99], v[40:43]
    v_exp_f32 v115, v115 clamp
    v_mfma_f32_16x16x32_bf16 v[44:47], v[64:67], v[100:103], v[44:47]
    v_exp_f32 v116, v116 clamp
    v_exp_f32 v117, v117 clamp
    v_exp_f32 v118, v118 clamp
    v_exp_f32 v119, v119 clamp
    v_max_f32 v104, s38, v104
    v_max_f32 v105, s38, v105
    v_max_f32 v106, s38, v106
    v_max_f32 v107, s38, v107
    v_max_f32 v108, s38, v108
    v_max_f32 v109, s38, v109
    v_max_f32 v110, s38, v110
    v_max_f32 v111, s38, v111
    v_pk_add_f32 v[104:105], v[112:113], v[104:105]
    v_pk_add_f32 v[106:107], v[114:115], v[106:107]
    v_pk_add_f32 v[108:109], v[116:117], v[108:109]
    v_pk_add_f32 v[110:111], v[118:119], v[110:111]
    v_cvt_pk_bf16_f32 v60, v104, v105
    s_waitcnt vmcnt(1) lgkmcnt(0)
    v_cvt_pk_bf16_f32 v61, v106, v107
    v_cvt_pk_bf16_f32 v62, v108, v109
    v_cvt_pk_bf16_f32 v63, v110, v111
    s_barrier
    ds_read_b64_tr_b16 v[96:97], v7 offset:57344
    ds_read_b64_tr_b16 v[98:99], v7 offset:59392
    ds_read_b64_tr_b16 v[100:101], v8 offset:57344
    ds_read_b64_tr_b16 v[102:103], v8 offset:59392
    ds_read_b64_tr_b16 v[88:89], v5 offset:57344
    ds_read_b64_tr_b16 v[90:91], v5 offset:59392
    ds_read_b64_tr_b16 v[92:93], v6 offset:57344
    ds_read_b64_tr_b16 v[94:95], v6 offset:59392
    v_mfma_f32_16x16x32_bf16 v[48:51], v[68:71], v[28:31], v[48:51]
    v_mfma_f32_16x16x32_bf16 v[32:35], v[68:71], v[72:75], v[32:35]
    v_mfma_f32_16x16x32_bf16 v[36:39], v[68:71], v[76:79], v[36:39]
    v_mfma_f32_16x16x32_bf16 v[40:43], v[68:71], v[80:83], v[40:43]
    v_mfma_f32_16x16x32_bf16 v[44:47], v[68:71], v[84:87], v[44:47]
    v_mfma_f32_16x16x32_bf16 v[48:51], v[60:63], v[28:31], v[48:51]
    s_waitcnt lgkmcnt(4)
    v_mfma_f32_16x16x32_bf16 v[40:43], v[60:63], v[96:99], v[40:43]
    v_mfma_f32_16x16x32_bf16 v[44:47], v[60:63], v[100:103], v[44:47]
    s_waitcnt lgkmcnt(0)
    v_mfma_f32_16x16x32_bf16 v[32:35], v[60:63], v[88:91], v[32:35]
    v_mfma_f32_16x16x32_bf16 v[36:39], v[60:63], v[92:95], v[36:39]
    s_nop 1
    ds_write_b128 v129, v[48:51] offset:2048
    s_nop 0
    ds_write_b128 v129, v[40:43]
    ds_write_b128 v129, v[44:47] offset:1024
    s_waitcnt lgkmcnt(0)
    s_barrier
    ds_read_b128 v[72:75], v130 offset:0
    ds_read_b128 v[76:79], v130 offset:1024
    ds_read_b128 v[80:83], v130 offset:2048
    s_waitcnt lgkmcnt(1)
    v_pk_add_f32 v[32:33], v[32:33], v[72:73]
    v_pk_add_f32 v[34:35], v[34:35], v[74:75]
    v_pk_add_f32 v[36:37], v[36:37], v[76:77]
    v_pk_add_f32 v[38:39], v[38:39], v[78:79]
    v_cvt_pk_bf16_f32 v60, v32, v33
    v_cvt_pk_bf16_f32 v61, v34, v35
    v_cvt_pk_bf16_f32 v62, v36, v37
    v_cvt_pk_bf16_f32 v63, v38, v39
    v_min_u32 v60, -2, v60
    v_min_u32_e64 v62, -2, v62
    buffer_store_dwordx4 v[60:63], v9, s[28:31], s43 offen nt
    s_waitcnt lgkmcnt(0)
    v_pk_add_f32 v[64:65], v[48:49], v[80:81]
    v_pk_add_f32 v[66:67], v[50:51], v[82:83]
    v_min_u32 v64, -2, v64
    v_min_u32_e64 v66, -2, v66
    buffer_store_dwordx4 v[64:67], v18, s[28:31], s4 offen
    s_add_u32 m0, s42, 0
    s_nop 0
    buffer_load_dwordx4 v10, s[16:19], s68 offen offset:0 nt lds
    buffer_load_dwordx4 v11, s[16:19], s68 offen offset:1024 nt lds
    buffer_load_dwordx4 v12, s[16:19], s68 offen offset:2048 nt lds
    buffer_load_dwordx4 v13, s[16:19], s68 offen offset:3072 nt lds
    s_nop 0
    s_waitcnt vmcnt(6)
L_hsL:
    v_cmp_ne_u64 vcc, s[0:1], v[120:121]
    s_cbranch_vccnz L_hrL
L_goL:
    s_barrier
    s_add_u32 m0, s42, 4096
    s_nop 0
    buffer_load_dwordx4 v10, s[16:19], s69 offen offset:0 nt lds
    buffer_load_dwordx4 v11, s[16:19], s69 offen offset:1024 nt lds
    buffer_load_dwordx4 v12, s[16:19], s69 offen offset:2048 nt lds
    buffer_load_dwordx4 v13, s[16:19], s69 offen offset:3072 nt lds
    s_waitcnt vmcnt(4)
    ds_read_b128 v[136:139], v14 offset:0
    ds_read_b128 v[140:143], v15 offset:0
    ds_read_b128 v[144:147], v16 offset:0
    ds_read_b128 v[148:151], v17 offset:0
    s_waitcnt lgkmcnt(3)
    v_lshlrev_b32 v104, 16, v136
    v_and_b32 v105, s39, v136
    v_lshlrev_b32 v106, 16, v137
    v_and_b32 v107, s39, v137
    v_lshlrev_b32 v108, 16, v138
    v_and_b32 v109, s39, v138
    v_lshlrev_b32 v110, 16, v139
    v_and_b32 v111, s39, v139
    v_pk_mul_f32 v[112:113], v[104:105], s[40:41]
    v_pk_mul_f32 v[114:115], v[106:107], s[40:41]
    v_pk_mul_f32 v[116:117], v[108:109], s[40:41]
    v_pk_mul_f32 v[118:119], v[110:111], s[40:41]
    v_exp_f32 v112, v112 clamp
    v_exp_f32 v113, v113 clamp
    v_exp_f32 v114, v114 clamp
    v_exp_f32 v115, v115 clamp
    v_exp_f32 v116, v116 clamp
    v_exp_f32 v117, v117 clamp
    v_exp_f32 v118, v118 clamp
    v_exp_f32 v119, v119 clamp
    v_max_f32 v104, s38, v104
    v_max_f32 v105, s38, v105
    v_max_f32 v106, s38, v106
    v_max_f32 v107, s38, v107
    v_max_f32 v108, s38, v108
    v_max_f32 v109, s38, v109
    v_max_f32 v110, s38, v110
    v_max_f32 v111, s38, v111
    v_pk_add_f32 v[104:105], v[112:113], v[104:105]
    v_pk_add_f32 v[106:107], v[114:115], v[106:107]
    v_pk_add_f32 v[108:109], v[116:117], v[108:109]
    v_pk_add_f32 v[110:111], v[118:119], v[110:111]
    v_cvt_pk_bf16_f32 v136, v104, v105
    v_cvt_pk_bf16_f32 v137, v106, v107
    v_cvt_pk_bf16_f32 v138, v108, v109
    v_cvt_pk_bf16_f32 v139, v110, v111
    s_waitcnt lgkmcnt(2)
    v_lshlrev_b32 v104, 16, v140
    v_and_b32 v105, s39, v140
    v_lshlrev_b32 v106, 16, v141
    v_and_b32 v107, s39, v141
    v_lshlrev_b32 v108, 16, v142
    v_and_b32 v109, s39, v142
    v_lshlrev_b32 v110, 16, v143
    v_and_b32_e64 v111, s39, v143
    v_pk_mul_f32 v[112:113], v[104:105], s[40:41]
    v_pk_mul_f32 v[114:115], v[106:107], s[40:41]
    v_pk_mul_f32 v[116:117], v[108:109], s[40:41]
    v_pk_mul_f32 v[118:119], v[110:111], s[40:41]
    v_exp_f32 v112, v112 clamp
    v_exp_f32 v113, v113 clamp
    v_exp_f32 v114, v114 clamp
    v_exp_f32 v115, v115 clamp
    v_exp_f32 v116, v116 clamp
    v_exp_f32 v117, v117 clamp
    v_exp_f32 v118, v118 clamp
    v_exp_f32 v119, v119 clamp
    v_max_f32 v104, s38, v104
    v_max_f32 v105, s38, v105
    v_max_f32 v106, s38, v106
    v_max_f32 v107, s38, v107
    v_max_f32 v108, s38, v108
    v_max_f32 v109, s38, v109
    v_max_f32 v110, s38, v110
    v_max_f32 v111, s38, v111
    v_pk_add_f32 v[104:105], v[112:113], v[104:105]
    v_pk_add_f32 v[106:107], v[114:115], v[106:107]
    v_pk_add_f32 v[108:109], v[116:117], v[108:109]
    v_pk_add_f32 v[110:111], v[118:119], v[110:111]
    v_cvt_pk_bf16_f32 v140, v104, v105
    v_cvt_pk_bf16_f32 v141, v106, v107
    v_cvt_pk_bf16_f32 v142, v108, v109
    v_cvt_pk_bf16_f32 v143, v110, v111
    s_waitcnt lgkmcnt(1)
    v_lshlrev_b32 v104, 16, v144
    v_and_b32 v105, s39, v144
    v_lshlrev_b32 v106, 16, v145
    v_and_b32 v107, s39, v145
    v_lshlrev_b32 v108, 16, v146
    v_and_b32 v109, s39, v146
    v_lshlrev_b32 v110, 16, v147
    v_and_b32_e64 v111, s39, v147
    v_pk_mul_f32 v[112:113], v[104:105], s[40:41]
    v_pk_mul_f32 v[114:115], v[106:107], s[40:41]
    v_pk_mul_f32 v[116:117], v[108:109], s[40:41]
    v_pk_mul_f32 v[118:119], v[110:111], s[40:41]
    v_exp_f32 v112, v112 clamp
    v_exp_f32 v113, v113 clamp
    v_exp_f32 v114, v114 clamp
    v_exp_f32 v115, v115 clamp
    v_exp_f32 v116, v116 clamp
    v_exp_f32 v117, v117 clamp
    v_exp_f32 v118, v118 clamp
    v_exp_f32 v119, v119 clamp
    v_max_f32 v104, s38, v104
    v_max_f32 v105, s38, v105
    v_max_f32 v106, s38, v106
    v_max_f32 v107, s38, v107
    v_max_f32 v108, s38, v108
    v_max_f32 v109, s38, v109
    v_max_f32 v110, s38, v110
    v_max_f32 v111, s38, v111
    v_pk_add_f32 v[104:105], v[112:113], v[104:105]
    v_pk_add_f32 v[106:107], v[114:115], v[106:107]
    v_pk_add_f32 v[108:109], v[116:117], v[108:109]
    v_pk_add_f32 v[110:111], v[118:119], v[110:111]
    v_cvt_pk_bf16_f32 v144, v104, v105
    v_cvt_pk_bf16_f32 v145, v106, v107
    v_cvt_pk_bf16_f32 v146, v108, v109
    v_cvt_pk_bf16_f32 v147, v110, v111
    s_waitcnt lgkmcnt(0)
    v_lshlrev_b32 v104, 16, v148
    v_and_b32 v105, s39, v148
    v_lshlrev_b32 v106, 16, v149
    v_and_b32 v107, s39, v149
    v_lshlrev_b32 v108, 16, v150
    v_and_b32 v109, s39, v150
    v_lshlrev_b32 v110, 16, v151
    v_and_b32_e64 v111, s39, v151
    v_pk_mul_f32 v[112:113], v[104:105], s[40:41]
    v_pk_mul_f32 v[114:115], v[106:107], s[40:41]
    v_pk_mul_f32 v[116:117], v[108:109], s[40:41]
    v_pk_mul_f32 v[118:119], v[110:111], s[40:41]
    v_exp_f32 v112, v112 clamp
    v_exp_f32 v113, v113 clamp
    v_exp_f32 v114, v114 clamp
    v_exp_f32 v115, v115 clamp
    v_exp_f32 v116, v116 clamp
    v_exp_f32 v117, v117 clamp
    v_exp_f32 v118, v118 clamp
    v_exp_f32 v119, v119 clamp
    v_max_f32 v104, s38, v104
    v_max_f32 v105, s38, v105
    v_max_f32 v106, s38, v106
    v_max_f32 v107, s38, v107
    v_max_f32 v108, s38, v108
    v_max_f32 v109, s38, v109
    v_max_f32 v110, s38, v110
    v_max_f32 v111, s38, v111
    v_pk_add_f32 v[104:105], v[112:113], v[104:105]
    v_pk_add_f32 v[106:107], v[114:115], v[106:107]
    v_pk_add_f32 v[108:109], v[116:117], v[108:109]
    v_pk_add_f32 v[110:111], v[118:119], v[110:111]
    v_cvt_pk_bf16_f32 v148, v104, v105
    v_cvt_pk_bf16_f32 v149, v106, v107
    v_cvt_pk_bf16_f32 v150, v108, v109
    v_cvt_pk_bf16_f32 v151, v110, v111
    s_barrier
    s_waitcnt vmcnt(0)
    ds_read_b128 v[152:155], v14 offset:4096
    ds_read_b128 v[156:159], v15 offset:4096
    ds_read_b128 v[160:163], v16 offset:4096
    ds_read_b128 v[164:167], v17 offset:4096
    s_waitcnt lgkmcnt(3)
    v_lshlrev_b32 v104, 16, v152
    v_and_b32 v105, s39, v152
    v_lshlrev_b32 v106, 16, v153
    v_and_b32 v107, s39, v153
    v_lshlrev_b32 v108, 16, v154
    v_and_b32 v109, s39, v154
    v_lshlrev_b32 v110, 16, v155
    v_and_b32 v111, s39, v155
    v_mul_f32 v112, s40, v104
    v_mul_f32 v113, s40, v105
    v_mul_f32 v114, s40, v106
    v_mul_f32 v115, s40, v107
    v_mul_f32 v116, s40, v108
    v_mul_f32 v117, s40, v109
    v_mul_f32 v118, s40, v110
    v_mul_f32_e64 v119, s40, v111
    v_exp_f32 v112, v112 clamp
    v_exp_f32 v113, v113 clamp
    v_exp_f32 v114, v114 clamp
    v_exp_f32 v115, v115 clamp
    v_exp_f32 v116, v116 clamp
    v_exp_f32 v117, v117 clamp
    v_exp_f32 v118, v118 clamp
    v_exp_f32 v119, v119 clamp
    v_max_f32 v104, s38, v104
    v_max_f32 v105, s38, v105
    v_max_f32 v106, s38, v106
    v_max_f32 v107, s38, v107
    v_max_f32 v108, s38, v108
    v_max_f32 v109, s38, v109
    v_max_f32 v110, s38, v110
    v_max_f32 v111, s38, v111
    v_add_f32 v104, v112, v104
    v_add_f32 v105, v113, v105
    v_add_f32 v106, v114, v106
    v_add_f32 v107, v115, v107
    v_add_f32 v108, v116, v108
    v_add_f32 v109, v117, v109
    v_add_f32 v110, v118, v110
    v_add_f32 v111, v119, v111
    v_cvt_pk_bf16_f32 v152, v104, v105
    v_cvt_pk_bf16_f32 v153, v106, v107
    v_cvt_pk_bf16_f32 v154, v108, v109
    v_cvt_pk_bf16_f32 v155, v110, v111
    s_waitcnt lgkmcnt(2)
    v_lshlrev_b32 v104, 16, v156
    v_and_b32 v105, s39, v156
    v_lshlrev_b32 v106, 16, v157
    v_and_b32 v107, s39, v157
    v_lshlrev_b32 v108, 16, v158
    v_and_b32 v109, s39, v158
    v_lshlrev_b32 v110, 16, v159
    v_and_b32 v111, s39, v159
    v_mul_f32 v112, s40, v104
    v_mul_f32 v113, s40, v105
    v_mul_f32 v114, s40, v106
    v_mul_f32 v115, s40, v107
    v_mul_f32 v116, s40, v108
    v_mul_f32 v117, s40, v109
    v_mul_f32 v118, s40, v110
    v_mul_f32_e64 v119, s40, v111
    v_exp_f32 v112, v112 clamp
    v_exp_f32 v113, v113 clamp
    v_exp_f32 v114, v114 clamp
    v_exp_f32 v115, v115 clamp
    v_exp_f32 v116, v116 clamp
    v_exp_f32 v117, v117 clamp
    v_exp_f32 v118, v118 clamp
    v_exp_f32 v119, v119 clamp
    v_max_f32 v104, s38, v104
    v_max_f32 v105, s38, v105
    v_max_f32 v106, s38, v106
    v_max_f32 v107, s38, v107
    v_max_f32 v108, s38, v108
    v_max_f32 v109, s38, v109
    v_max_f32 v110, s38, v110
    v_max_f32 v111, s38, v111
    v_add_f32 v104, v112, v104
    v_add_f32 v105, v113, v105
    v_add_f32 v106, v114, v106
    v_add_f32 v107, v115, v107
    v_add_f32 v108, v116, v108
    v_add_f32 v109, v117, v109
    v_add_f32 v110, v118, v110
    v_add_f32 v111, v119, v111
    v_cvt_pk_bf16_f32 v156, v104, v105
    v_cvt_pk_bf16_f32 v157, v106, v107
    v_cvt_pk_bf16_f32 v158, v108, v109
    v_cvt_pk_bf16_f32 v159, v110, v111
    s_waitcnt lgkmcnt(1)
    v_lshlrev_b32 v104, 16, v160
    v_and_b32 v105, s39, v160
    v_lshlrev_b32 v106, 16, v161
    v_and_b32 v107, s39, v161
    v_lshlrev_b32 v108, 16, v162
    v_and_b32 v109, s39, v162
    v_lshlrev_b32 v110, 16, v163
    v_and_b32 v111, s39, v163
    v_mul_f32 v112, s40, v104
    v_mul_f32 v113, s40, v105
    v_mul_f32 v114, s40, v106
    v_mul_f32 v115, s40, v107
    v_mul_f32 v116, s40, v108
    v_mul_f32 v117, s40, v109
    v_mul_f32 v118, s40, v110
    v_mul_f32_e64 v119, s40, v111
    v_exp_f32 v112, v112 clamp
    v_exp_f32 v113, v113 clamp
    v_exp_f32 v114, v114 clamp
    v_exp_f32 v115, v115 clamp
    v_exp_f32 v116, v116 clamp
    v_exp_f32 v117, v117 clamp
    v_exp_f32 v118, v118 clamp
    v_exp_f32 v119, v119 clamp
    v_max_f32 v104, s38, v104
    v_max_f32 v105, s38, v105
    v_max_f32 v106, s38, v106
    v_max_f32 v107, s38, v107
    v_max_f32 v108, s38, v108
    v_max_f32 v109, s38, v109
    v_max_f32 v110, s38, v110
    v_max_f32 v111, s38, v111
    v_add_f32 v104, v112, v104
    v_add_f32 v105, v113, v105
    v_add_f32 v106, v114, v106
    v_add_f32 v107, v115, v107
    v_add_f32 v108, v116, v108
    v_add_f32 v109, v117, v109
    v_add_f32 v110, v118, v110
    v_add_f32 v111, v119, v111
    v_cvt_pk_bf16_f32 v160, v104, v105
    v_cvt_pk_bf16_f32 v161, v106, v107
    v_cvt_pk_bf16_f32 v162, v108, v109
    v_cvt_pk_bf16_f32 v163, v110, v111
    s_waitcnt lgkmcnt(0)
    v_lshlrev_b32 v104, 16, v164
    v_and_b32 v105, s39, v164
    v_lshlrev_b32 v106, 16, v165
    v_and_b32 v107, s39, v165
    v_lshlrev_b32 v108, 16, v166
    v_and_b32 v109, s39, v166
    v_lshlrev_b32 v110, 16, v167
    v_and_b32 v111, s39, v167
    v_mul_f32 v112, s40, v104
    v_mul_f32 v113, s40, v105
    v_mul_f32 v114, s40, v106
    v_mul_f32 v115, s40, v107
    v_mul_f32 v116, s40, v108
    v_mul_f32 v117, s40, v109
    v_mul_f32 v118, s40, v110
    v_mul_f32_e64 v119, s40, v111
    v_exp_f32 v112, v112 clamp
    v_exp_f32 v113, v113 clamp
    v_exp_f32 v114, v114 clamp
    v_exp_f32 v115, v115 clamp
    v_exp_f32 v116, v116 clamp
    v_exp_f32 v117, v117 clamp
    v_exp_f32 v118, v118 clamp
    v_exp_f32 v119, v119 clamp
    v_max_f32 v104, s38, v104
    v_max_f32 v105, s38, v105
    v_max_f32 v106, s38, v106
    v_max_f32 v107, s38, v107
    v_max_f32 v108, s38, v108
    v_max_f32 v109, s38, v109
    v_max_f32 v110, s38, v110
    v_max_f32 v111, s38, v111
    v_add_f32 v104, v112, v104
    v_add_f32 v105, v113, v105
    v_add_f32 v106, v114, v106
    v_add_f32 v107, v115, v107
    v_add_f32 v108, v116, v108
    v_add_f32 v109, v117, v109
    v_add_f32 v110, v118, v110
    v_add_f32 v111, v119, v111
    v_cvt_pk_bf16_f32 v164, v104, v105
    v_cvt_pk_bf16_f32 v165, v106, v107
    v_cvt_pk_bf16_f32 v166, v108, v109
    v_cvt_pk_bf16_f32 v167, v110, v111
    s_waitcnt lgkmcnt(0)
    s_branch L_mm
L_E:
    s_barrier
    v_lshlrev_b32 v104, 16, v56
    v_and_b32_e64 v105, s39, v56
    ds_read_b64_tr_b16 v[72:73], v5 offset:16384
    v_lshlrev_b32 v106, 16, v57
    v_and_b32 v107, s39, v57
    ds_read_b64_tr_b16 v[74:75], v5 offset:18432
    v_lshlrev_b32 v108, 16, v58
    v_and_b32 v109, s39, v58
    ds_read_b64_tr_b16 v[76:77], v6 offset:16384
    v_lshlrev_b32 v110, 16, v59
    v_and_b32 v111, s39, v59
    ds_read_b64_tr_b16 v[78:79], v6 offset:18432
    v_pk_mul_f32 v[112:113], v[104:105], s[40:41]
    v_pk_mul_f32 v[114:115], v[106:107], s[40:41]
    ds_read_b64_tr_b16 v[80:81], v7 offset:16384
    v_pk_mul_f32 v[116:117], v[108:109], s[40:41]
    v_pk_mul_f32 v[118:119], v[110:111], s[40:41]
    ds_read_b64_tr_b16 v[82:83], v7 offset:18432
    v_mfma_f32_16x16x32_bf16 v[48:51], v[60:63], v[28:31], v[48:51]
    v_exp_f32 v112, v112 clamp
    ds_read_b64_tr_b16 v[84:85], v8 offset:16384
    v_mfma_f32_16x16x32_bf16 v[32:35], v[60:63], v[88:91], v[32:35]
    v_exp_f32 v113, v113 clamp
    ds_read_b64_tr_b16 v[86:87], v8 offset:18432
    v_mfma_f32_16x16x32_bf16 v[36:39], v[60:63], v[92:95], v[36:39]
    v_exp_f32 v114, v114 clamp
    ds_read_b64_tr_b16 v[52:53], v4 offset:32768
    v_mfma_f32_16x16x32_bf16 v[40:43], v[60:63], v[96:99], v[40:43]
    v_exp_f32 v115, v115 clamp
    ds_read_b64_tr_b16 v[54:55], v4 offset:34816
    v_mfma_f32_16x16x32_bf16 v[44:47], v[60:63], v[100:103], v[44:47]
    v_exp_f32 v116, v116 clamp
    v_exp_f32 v117, v117 clamp
    v_exp_f32 v118, v118 clamp
    v_exp_f32 v119, v119 clamp
    v_max_f32 v104, s38, v104
    v_max_f32 v105, s38, v105
    v_max_f32 v106, s38, v106
    v_max_f32 v107, s38, v107
    v_max_f32 v108, s38, v108
    v_max_f32 v109, s38, v109
    v_max_f32 v110, s38, v110
    v_max_f32 v111, s38, v111
    v_pk_add_f32 v[104:105], v[112:113], v[104:105]
    v_pk_add_f32 v[106:107], v[114:115], v[106:107]
    s_add_u32 m0, s35, 114688
    v_pk_add_f32 v[108:109], v[116:117], v[108:109]
    buffer_load_dwordx4 v3, s[12:15], s58 offen nt lds
    v_pk_add_f32 v[110:111], v[118:119], v[110:111]
    v_cvt_pk_bf16_f32 v68, v104, v105
    s_waitcnt vmcnt(5) lgkmcnt(0)
    v_cvt_pk_bf16_f32 v69, v106, v107
    v_cvt_pk_bf16_f32 v70, v108, v109
    v_cvt_pk_bf16_f32 v71, v110, v111
    s_barrier
    v_lshlrev_b32 v104, 16, v52
    v_and_b32 v105, s39, v52
    ds_read_b64_tr_b16 v[88:89], v5 offset:24576
    v_lshlrev_b32 v106, 16, v53
    v_and_b32 v107, s39, v53
    ds_read_b64_tr_b16 v[90:91], v5 offset:26624
    v_lshlrev_b32 v108, 16, v54
    v_and_b32 v109, s39, v54
    ds_read_b64_tr_b16 v[92:93], v6 offset:24576
    v_lshlrev_b32 v110, 16, v55
    v_and_b32 v111, s39, v55
    ds_read_b64_tr_b16 v[94:95], v6 offset:26624
    v_pk_mul_f32 v[112:113], v[104:105], s[40:41]
    v_pk_mul_f32 v[114:115], v[106:107], s[40:41]
    ds_read_b64_tr_b16 v[96:97], v7 offset:24576
    v_pk_mul_f32 v[116:117], v[108:109], s[40:41]
    v_pk_mul_f32 v[118:119], v[110:111], s[40:41]
    ds_read_b64_tr_b16 v[98:99], v7 offset:26624
    v_mfma_f32_16x16x32_bf16 v[48:51], v[64:67], v[28:31], v[48:51]
    v_exp_f32 v112, v112 clamp
    ds_read_b64_tr_b16 v[100:101], v8 offset:24576
    v_mfma_f32_16x16x32_bf16 v[32:35], v[64:67], v[72:75], v[32:35]
    v_exp_f32 v113, v113 clamp
    ds_read_b64_tr_b16 v[102:103], v8 offset:26624
    v_mfma_f32_16x16x32_bf16 v[36:39], v[64:67], v[76:79], v[36:39]
    v_exp_f32 v114, v114 clamp
    ds_read_b64_tr_b16 v[56:57], v4 offset:40960
    v_mfma_f32_16x16x32_bf16 v[40:43], v[64:67], v[80:83], v[40:43]
    v_exp_f32 v115, v115 clamp
    ds_read_b64_tr_b16 v[58:59], v4 offset:43008
    v_mfma_f32_16x16x32_bf16 v[44:47], v[64:67], v[84:87], v[44:47]
    v_exp_f32 v116, v116 clamp
    v_exp_f32 v117, v117 clamp
    v_exp_f32 v118, v118 clamp
    v_exp_f32 v119, v119 clamp
    v_max_f32 v104, s38, v104
    v_max_f32 v105, s38, v105
    v_max_f32 v106, s38, v106
    v_max_f32 v107, s38, v107
    v_max_f32 v108, s38, v108
    v_max_f32 v109, s38, v109
    v_max_f32 v110, s38, v110
    v_max_f32 v111, s38, v111
    v_pk_add_f32 v[104:105], v[112:113], v[104:105]
    s_add_u32 m0, s35, 122880
    v_pk_add_f32 v[106:107], v[114:115], v[106:107]
    buffer_load_dwordx4 v3, s[12:15], s59 offen nt lds
    v_pk_add_f32 v[108:109], v[116:117], v[108:109]
    buffer_load_dwordx2 v[120:121], v123, s[24:27], s7 offen sc1
    v_pk_add_f32 v[110:111], v[118:119], v[110:111]
    v_cvt_pk_bf16_f32 v60, v104, v105
    s_waitcnt vmcnt(5) lgkmcnt(0)
    v_cvt_pk_bf16_f32 v61, v106, v107
    v_cvt_pk_bf16_f32 v62, v108, v109
    v_cvt_pk_bf16_f32 v63, v110, v111
    s_barrier
    v_lshlrev_b32 v104, 16, v56
    v_and_b32 v105, s39, v56
    ds_read_b64_tr_b16 v[72:73], v5 offset:32768
    v_lshlrev_b32 v106, 16, v57
    v_and_b32 v107, s39, v57
    ds_read_b64_tr_b16 v[74:75], v5 offset:34816
    v_lshlrev_b32 v108, 16, v58
    v_and_b32 v109, s39, v58
    ds_read_b64_tr_b16 v[76:77], v6 offset:32768
    v_lshlrev_b32 v110, 16, v59
    v_and_b32 v111, s39, v59
    ds_read_b64_tr_b16 v[78:79], v6 offset:34816
    v_pk_mul_f32 v[112:113], v[104:105], s[40:41]
    v_pk_mul_f32 v[114:115], v[106:107], s[40:41]
    ds_read_b64_tr_b16 v[80:81], v7 offset:32768
    v_pk_mul_f32 v[116:117], v[108:109], s[40:41]
    v_pk_mul_f32 v[118:119], v[110:111], s[40:41]
    ds_read_b64_tr_b16 v[82:83], v7 offset:34816
    v_mfma_f32_16x16x32_bf16 v[48:51], v[68:71], v[28:31], v[48:51]
    v_exp_f32 v112, v112 clamp
    ds_read_b64_tr_b16 v[84:85], v8 offset:32768
    v_mfma_f32_16x16x32_bf16 v[32:35], v[68:71], v[88:91], v[32:35]
    v_exp_f32 v113, v113 clamp
    ds_read_b64_tr_b16 v[86:87], v8 offset:34816
    v_mfma_f32_16x16x32_bf16 v[36:39], v[68:71], v[92:95], v[36:39]
    v_exp_f32 v114, v114 clamp
    ds_read_b64_tr_b16 v[52:53], v4 offset:49152
    v_mfma_f32_16x16x32_bf16 v[40:43], v[68:71], v[96:99], v[40:43]
    v_exp_f32 v115, v115 clamp
    ds_read_b64_tr_b16 v[54:55], v4 offset:51200
    v_mfma_f32_16x16x32_bf16 v[44:47], v[68:71], v[100:103], v[44:47]
    v_exp_f32 v116, v116 clamp
    v_exp_f32 v117, v117 clamp
    v_exp_f32 v118, v118 clamp
    v_exp_f32 v119, v119 clamp
    v_max_f32 v104, s38, v104
    v_max_f32 v105, s38, v105
    v_max_f32 v106, s38, v106
    v_max_f32 v107, s38, v107
    v_max_f32 v108, s38, v108
    v_max_f32 v109, s38, v109
    v_max_f32 v110, s38, v110
    s_add_u32 m0, s42, 0
    v_max_f32_e64 v111, s38, v111
    buffer_load_dwordx4 v10, s[16:19], s68 offen offset:0 nt lds
    v_pk_add_f32 v[104:105], v[112:113], v[104:105]
    buffer_load_dwordx4 v11, s[16:19], s68 offen offset:1024 nt lds
    v_pk_add_f32 v[106:107], v[114:115], v[106:107]
    buffer_load_dwordx4 v12, s[16:19], s68 offen offset:2048 nt lds
    v_pk_add_f32 v[108:109], v[116:117], v[108:109]
    buffer_load_dwordx4 v13, s[16:19], s68 offen offset:3072 nt lds
    v_pk_add_f32 v[110:111], v[118:119], v[110:111]
    v_cvt_pk_bf16_f32 v64, v104, v105
    s_waitcnt vmcnt(7) lgkmcnt(0)
    v_cvt_pk_bf16_f32 v65, v106, v107
    v_cvt_pk_bf16_f32 v66, v108, v109
    v_cvt_pk_bf16_f32 v67, v110, v111
    s_barrier
    v_lshlrev_b32 v104, 16, v52
    v_and_b32 v105, s39, v52
    ds_read_b64_tr_b16 v[88:89], v5 offset:40960
    v_lshlrev_b32 v106, 16, v53
    v_and_b32 v107, s39, v53
    ds_read_b64_tr_b16 v[90:91], v5 offset:43008
    v_lshlrev_b32 v108, 16, v54
    v_and_b32 v109, s39, v54
    ds_read_b64_tr_b16 v[92:93], v6 offset:40960
    v_lshlrev_b32 v110, 16, v55
    v_and_b32 v111, s39, v55
    ds_read_b64_tr_b16 v[94:95], v6 offset:43008
    v_pk_mul_f32 v[112:113], v[104:105], s[40:41]
    v_pk_mul_f32 v[114:115], v[106:107], s[40:41]
    ds_read_b64_tr_b16 v[96:97], v7 offset:40960
    v_pk_mul_f32 v[116:117], v[108:109], s[40:41]
    v_pk_mul_f32 v[118:119], v[110:111], s[40:41]
    ds_read_b64_tr_b16 v[98:99], v7 offset:43008
    v_mfma_f32_16x16x32_bf16 v[48:51], v[60:63], v[28:31], v[48:51]
    v_exp_f32 v112, v112 clamp
    ds_read_b64_tr_b16 v[100:101], v8 offset:40960
    v_mfma_f32_16x16x32_bf16 v[32:35], v[60:63], v[72:75], v[32:35]
    v_exp_f32 v113, v113 clamp
    ds_read_b64_tr_b16 v[102:103], v8 offset:43008
    v_mfma_f32_16x16x32_bf16 v[36:39], v[60:63], v[76:79], v[36:39]
    v_exp_f32 v114, v114 clamp
    ds_read_b64_tr_b16 v[56:57], v4 offset:57344
    v_mfma_f32_16x16x32_bf16 v[40:43], v[60:63], v[80:83], v[40:43]
    v_exp_f32 v115, v115 clamp
    ds_read_b64_tr_b16 v[58:59], v4 offset:59392
    v_mfma_f32_16x16x32_bf16 v[44:47], v[60:63], v[84:87], v[44:47]
    v_exp_f32 v116, v116 clamp
    v_exp_f32 v117, v117 clamp
    v_exp_f32 v118, v118 clamp
    v_exp_f32 v119, v119 clamp
    v_max_f32 v104, s38, v104
    v_max_f32 v105, s38, v105
    v_max_f32 v106, s38, v106
    v_max_f32 v107, s38, v107
    v_max_f32 v108, s38, v108
    v_max_f32 v109, s38, v109
    v_max_f32_e64 v110, s38, v110
    s_add_u32 m0, s42, 4096
    v_max_f32_e64 v111, s38, v111
    buffer_load_dwordx4 v10, s[16:19], s69 offen offset:0 nt lds
    v_pk_add_f32 v[104:105], v[112:113], v[104:105]
    buffer_load_dwordx4 v11, s[16:19], s69 offen offset:1024 nt lds
    v_pk_add_f32 v[106:107], v[114:115], v[106:107]
    buffer_load_dwordx4 v12, s[16:19], s69 offen offset:2048 nt lds
    v_pk_add_f32 v[108:109], v[116:117], v[108:109]
    buffer_load_dwordx4 v13, s[16:19], s69 offen offset:3072 nt lds
    v_pk_add_f32 v[110:111], v[118:119], v[110:111]
    v_cvt_pk_bf16_f32 v68, v104, v105
    s_waitcnt vmcnt(10) lgkmcnt(0)
    v_cvt_pk_bf16_f32 v69, v106, v107
    v_cvt_pk_bf16_f32 v70, v108, v109
    v_cvt_pk_bf16_f32 v71, v110, v111
    s_barrier
    v_lshlrev_b32 v104, 16, v56
    v_and_b32 v105, s39, v56
    ds_read_b64_tr_b16 v[72:73], v5 offset:49152
    v_lshlrev_b32 v106, 16, v57
    v_and_b32 v107, s39, v57
    ds_read_b64_tr_b16 v[74:75], v5 offset:51200
    v_lshlrev_b32 v108, 16, v58
    v_and_b32 v109, s39, v58
    ds_read_b64_tr_b16 v[76:77], v6 offset:49152
    v_lshlrev_b32 v110, 16, v59
    v_and_b32 v111, s39, v59
    ds_read_b64_tr_b16 v[78:79], v6 offset:51200
    v_pk_mul_f32 v[112:113], v[104:105], s[40:41]
    v_pk_mul_f32 v[114:115], v[106:107], s[40:41]
    ds_read_b64_tr_b16 v[80:81], v7 offset:49152
    v_pk_mul_f32 v[116:117], v[108:109], s[40:41]
    v_pk_mul_f32 v[118:119], v[110:111], s[40:41]
    ds_read_b64_tr_b16 v[82:83], v7 offset:51200
    v_mfma_f32_16x16x32_bf16 v[48:51], v[64:67], v[28:31], v[48:51]
    v_exp_f32 v112, v112 clamp
    ds_read_b64_tr_b16 v[84:85], v8 offset:49152
    v_mfma_f32_16x16x32_bf16 v[32:35], v[64:67], v[88:91], v[32:35]
    v_exp_f32 v113, v113 clamp
    ds_read_b64_tr_b16 v[86:87], v8 offset:51200
    v_mfma_f32_16x16x32_bf16 v[36:39], v[64:67], v[92:95], v[36:39]
    v_exp_f32 v114, v114 clamp
    v_mfma_f32_16x16x32_bf16 v[40:43], v[64:67], v[96:99], v[40:43]
    v_exp_f32 v115, v115 clamp
    v_mfma_f32_16x16x32_bf16 v[44:47], v[64:67], v[100:103], v[44:47]
    v_exp_f32 v116, v116 clamp
    v_exp_f32 v117, v117 clamp
    v_exp_f32 v118, v118 clamp
    v_exp_f32 v119, v119 clamp
    v_max_f32 v104, s38, v104
    v_max_f32 v105, s38, v105
    v_max_f32 v106, s38, v106
    v_max_f32 v107, s38, v107
    v_max_f32 v108, s38, v108
    v_max_f32 v109, s38, v109
    v_max_f32 v110, s38, v110
    v_max_f32 v111, s38, v111
    v_pk_add_f32 v[104:105], v[112:113], v[104:105]
    v_pk_add_f32 v[106:107], v[114:115], v[106:107]
    v_pk_add_f32 v[108:109], v[116:117], v[108:109]
    v_pk_add_f32 v[110:111], v[118:119], v[110:111]
    v_cvt_pk_bf16_f32 v60, v104, v105
    s_waitcnt vmcnt(9) lgkmcnt(0)
    v_cvt_pk_bf16_f32 v61, v106, v107
    v_cvt_pk_bf16_f32 v62, v108, v109
    v_cvt_pk_bf16_f32 v63, v110, v111
    s_barrier
    ds_read_b64_tr_b16 v[96:97], v7 offset:57344
    ds_read_b64_tr_b16 v[98:99], v7 offset:59392
    ds_read_b64_tr_b16 v[100:101], v8 offset:57344
    ds_read_b64_tr_b16 v[102:103], v8 offset:59392
    ds_read_b64_tr_b16 v[88:89], v5 offset:57344
    ds_read_b64_tr_b16 v[90:91], v5 offset:59392
    ds_read_b64_tr_b16 v[92:93], v6 offset:57344
    ds_read_b64_tr_b16 v[94:95], v6 offset:59392
    v_mfma_f32_16x16x32_bf16 v[48:51], v[68:71], v[28:31], v[48:51]
    v_mfma_f32_16x16x32_bf16 v[32:35], v[68:71], v[72:75], v[32:35]
    v_mfma_f32_16x16x32_bf16 v[36:39], v[68:71], v[76:79], v[36:39]
    v_mfma_f32_16x16x32_bf16 v[40:43], v[68:71], v[80:83], v[40:43]
    v_mfma_f32_16x16x32_bf16 v[44:47], v[68:71], v[84:87], v[44:47]
    v_mfma_f32_16x16x32_bf16 v[48:51], v[60:63], v[28:31], v[48:51]
    s_waitcnt lgkmcnt(4)
    v_mfma_f32_16x16x32_bf16 v[40:43], v[60:63], v[96:99], v[40:43]
    v_mfma_f32_16x16x32_bf16 v[44:47], v[60:63], v[100:103], v[44:47]
    s_waitcnt lgkmcnt(0)
    v_mfma_f32_16x16x32_bf16 v[32:35], v[60:63], v[88:91], v[32:35]
    v_mfma_f32_16x16x32_bf16 v[36:39], v[60:63], v[92:95], v[36:39]
    s_nop 1
    ds_write_b128 v129, v[48:51] offset:2048
    s_nop 0
    ds_write_b128 v129, v[40:43]
    ds_write_b128 v129, v[44:47] offset:1024
    s_waitcnt lgkmcnt(0)
    s_barrier
    ds_read_b128 v[72:75], v130 offset:0
    ds_read_b128 v[76:79], v130 offset:1024
    ds_read_b128 v[80:83], v130 offset:2048
    s_waitcnt lgkmcnt(1)
    v_pk_add_f32 v[32:33], v[32:33], v[72:73]
    v_pk_add_f32 v[34:35], v[34:35], v[74:75]
    v_pk_add_f32 v[36:37], v[36:37], v[76:77]
    v_pk_add_f32 v[38:39], v[38:39], v[78:79]
    v_cvt_pk_bf16_f32 v60, v32, v33
    v_cvt_pk_bf16_f32 v61, v34, v35
    v_cvt_pk_bf16_f32 v62, v36, v37
    v_cvt_pk_bf16_f32 v63, v38, v39
    v_min_u32 v60, -2, v60
    v_min_u32_e64 v62, -2, v62
    buffer_store_dwordx4 v[60:63], v9, s[28:31], s43 offen nt
    s_waitcnt lgkmcnt(0)
    v_pk_add_f32 v[64:65], v[48:49], v[80:81]
    v_pk_add_f32 v[66:67], v[50:51], v[82:83]
    v_min_u32 v64, -2, v64
    v_min_u32_e64 v66, -2, v66
    buffer_store_dwordx4 v[64:67], v18, s[28:31], s4 offen
    s_nop 0
    s_setprio 1
    s_waitcnt vmcnt(6)
    ds_read_b128 v[136:139], v14 offset:0
    ds_read_b128 v[140:143], v15 offset:0
    ds_read_b128 v[144:147], v16 offset:0
    ds_read_b128 v[148:151], v17 offset:0
    s_waitcnt lgkmcnt(3)
    v_lshlrev_b32 v104, 16, v136
    v_and_b32 v105, s39, v136
    v_lshlrev_b32 v106, 16, v137
    v_and_b32 v107, s39, v137
    v_lshlrev_b32 v108, 16, v138
    v_and_b32 v109, s39, v138
    v_lshlrev_b32 v110, 16, v139
    v_and_b32 v111, s39, v139
    v_pk_mul_f32 v[112:113], v[104:105], s[40:41]
    v_pk_mul_f32 v[114:115], v[106:107], s[40:41]
    v_pk_mul_f32 v[116:117], v[108:109], s[40:41]
    v_pk_mul_f32 v[118:119], v[110:111], s[40:41]
    v_exp_f32 v112, v112 clamp
    v_exp_f32 v113, v113 clamp
    v_exp_f32 v114, v114 clamp
    v_exp_f32 v115, v115 clamp
    v_exp_f32 v116, v116 clamp
    v_exp_f32 v117, v117 clamp
    v_exp_f32 v118, v118 clamp
    v_exp_f32 v119, v119 clamp
    v_max_f32 v104, s38, v104
    v_max_f32 v105, s38, v105
    v_max_f32 v106, s38, v106
    v_max_f32 v107, s38, v107
    v_max_f32 v108, s38, v108
    v_max_f32 v109, s38, v109
    v_max_f32 v110, s38, v110
    v_max_f32 v111, s38, v111
    v_pk_add_f32 v[104:105], v[112:113], v[104:105]
    v_pk_add_f32 v[106:107], v[114:115], v[106:107]
    v_pk_add_f32 v[108:109], v[116:117], v[108:109]
    v_pk_add_f32 v[110:111], v[118:119], v[110:111]
    v_cvt_pk_bf16_f32 v136, v104, v105
    v_cvt_pk_bf16_f32 v137, v106, v107
    v_cvt_pk_bf16_f32 v138, v108, v109
    v_cvt_pk_bf16_f32 v139, v110, v111
    s_waitcnt lgkmcnt(2)
    v_lshlrev_b32 v104, 16, v140
    v_and_b32 v105, s39, v140
    v_lshlrev_b32 v106, 16, v141
    v_and_b32 v107, s39, v141
    v_lshlrev_b32 v108, 16, v142
    v_and_b32 v109, s39, v142
    v_lshlrev_b32 v110, 16, v143
    v_and_b32_e64 v111, s39, v143
    v_pk_mul_f32 v[112:113], v[104:105], s[40:41]
    v_pk_mul_f32 v[114:115], v[106:107], s[40:41]
    v_pk_mul_f32 v[116:117], v[108:109], s[40:41]
    v_pk_mul_f32 v[118:119], v[110:111], s[40:41]
    v_exp_f32 v112, v112 clamp
    v_exp_f32 v113, v113 clamp
    v_exp_f32 v114, v114 clamp
    v_exp_f32 v115, v115 clamp
    v_exp_f32 v116, v116 clamp
    v_exp_f32 v117, v117 clamp
    v_exp_f32 v118, v118 clamp
    v_exp_f32 v119, v119 clamp
    v_max_f32 v104, s38, v104
    v_max_f32 v105, s38, v105
    v_max_f32 v106, s38, v106
    v_max_f32 v107, s38, v107
    v_max_f32 v108, s38, v108
    v_max_f32 v109, s38, v109
    v_max_f32 v110, s38, v110
    v_max_f32 v111, s38, v111
    v_pk_add_f32 v[104:105], v[112:113], v[104:105]
    v_pk_add_f32 v[106:107], v[114:115], v[106:107]
    v_pk_add_f32 v[108:109], v[116:117], v[108:109]
    v_pk_add_f32 v[110:111], v[118:119], v[110:111]
    v_cvt_pk_bf16_f32 v140, v104, v105
    v_cvt_pk_bf16_f32 v141, v106, v107
    v_cvt_pk_bf16_f32 v142, v108, v109
    v_cvt_pk_bf16_f32 v143, v110, v111
    s_waitcnt vmcnt(2)
    ds_read_b128 v[152:155], v14 offset:4096
    ds_read_b128 v[156:159], v15 offset:4096
    ds_read_b128 v[160:163], v16 offset:4096
    ds_read_b128 v[164:167], v17 offset:4096
    s_waitcnt lgkmcnt(5)
    v_lshlrev_b32 v104, 16, v144
    v_and_b32 v105, s39, v144
    v_lshlrev_b32 v106, 16, v145
    v_and_b32 v107, s39, v145
    v_lshlrev_b32 v108, 16, v146
    v_and_b32 v109, s39, v146
    v_lshlrev_b32 v110, 16, v147
    v_and_b32 v111, s39, v147
    v_pk_mul_f32 v[112:113], v[104:105], s[40:41]
    v_pk_mul_f32 v[114:115], v[106:107], s[40:41]
    v_pk_mul_f32 v[116:117], v[108:109], s[40:41]
    v_pk_mul_f32 v[118:119], v[110:111], s[40:41]
    v_exp_f32 v112, v112 clamp
    v_exp_f32 v113, v113 clamp
    v_exp_f32 v114, v114 clamp
    v_exp_f32 v115, v115 clamp
    v_exp_f32 v116, v116 clamp
    v_exp_f32 v117, v117 clamp
    v_exp_f32 v118, v118 clamp
    v_exp_f32 v119, v119 clamp
    v_max_f32 v104, s38, v104
    v_max_f32 v105, s38, v105
    v_max_f32 v106, s38, v106
    v_max_f32 v107, s38, v107
    v_max_f32 v108, s38, v108
    v_max_f32 v109, s38, v109
    v_max_f32 v110, s38, v110
    v_max_f32 v111, s38, v111
    v_pk_add_f32 v[104:105], v[112:113], v[104:105]
    v_pk_add_f32 v[106:107], v[114:115], v[106:107]
    v_pk_add_f32 v[108:109], v[116:117], v[108:109]
    v_pk_add_f32 v[110:111], v[118:119], v[110:111]
    v_cvt_pk_bf16_f32 v144, v104, v105
    v_cvt_pk_bf16_f32 v145, v106, v107
    v_cvt_pk_bf16_f32 v146, v108, v109
    v_cvt_pk_bf16_f32 v147, v110, v111
    s_waitcnt lgkmcnt(4)
    v_lshlrev_b32 v104, 16, v148
    v_and_b32 v105, s39, v148
    v_lshlrev_b32 v106, 16, v149
    v_and_b32 v107, s39, v149
    v_lshlrev_b32 v108, 16, v150
    v_and_b32 v109, s39, v150
    v_lshlrev_b32 v110, 16, v151
    v_and_b32_e64 v111, s39, v151
    v_pk_mul_f32 v[112:113], v[104:105], s[40:41]
    v_pk_mul_f32 v[114:115], v[106:107], s[40:41]
    v_pk_mul_f32 v[116:117], v[108:109], s[40:41]
    v_pk_mul_f32 v[118:119], v[110:111], s[40:41]
    v_exp_f32 v112, v112 clamp
    v_exp_f32 v113, v113 clamp
    v_exp_f32 v114, v114 clamp
    v_exp_f32 v115, v115 clamp
    v_exp_f32 v116, v116 clamp
    v_exp_f32 v117, v117 clamp
    v_exp_f32 v118, v118 clamp
    v_exp_f32 v119, v119 clamp
    v_max_f32 v104, s38, v104
    v_max_f32 v105, s38, v105
    v_max_f32 v106, s38, v106
    v_max_f32 v107, s38, v107
    v_max_f32 v108, s38, v108
    v_max_f32 v109, s38, v109
    v_max_f32 v110, s38, v110
    v_max_f32 v111, s38, v111
    v_pk_add_f32 v[104:105], v[112:113], v[104:105]
    v_pk_add_f32 v[106:107], v[114:115], v[106:107]
    v_pk_add_f32 v[108:109], v[116:117], v[108:109]
    v_pk_add_f32 v[110:111], v[118:119], v[110:111]
    v_cvt_pk_bf16_f32 v148, v104, v105
    v_cvt_pk_bf16_f32 v149, v106, v107
    v_cvt_pk_bf16_f32 v150, v108, v109
    v_cvt_pk_bf16_f32 v151, v110, v111
    s_waitcnt lgkmcnt(3)
    v_lshlrev_b32 v104, 16, v152
    v_and_b32 v105, s39, v152
    v_lshlrev_b32 v106, 16, v153
    v_and_b32 v107, s39, v153
    v_lshlrev_b32 v108, 16, v154
    v_and_b32 v109, s39, v154
    v_lshlrev_b32 v110, 16, v155
    v_and_b32_e64 v111, s39, v155
    v_pk_mul_f32 v[112:113], v[104:105], s[40:41]
    v_pk_mul_f32 v[114:115], v[106:107], s[40:41]
    v_pk_mul_f32 v[116:117], v[108:109], s[40:41]
    v_pk_mul_f32 v[118:119], v[110:111], s[40:41]
    v_exp_f32 v112, v112 clamp
    v_exp_f32 v113, v113 clamp
    v_exp_f32 v114, v114 clamp
    v_exp_f32 v115, v115 clamp
    v_exp_f32 v116, v116 clamp
    v_exp_f32 v117, v117 clamp
    v_exp_f32 v118, v118 clamp
    v_exp_f32 v119, v119 clamp
    v_max_f32 v104, s38, v104
    v_max_f32 v105, s38, v105
    v_max_f32 v106, s38, v106
    v_max_f32 v107, s38, v107
    v_max_f32 v108, s38, v108
    v_max_f32 v109, s38, v109
    v_max_f32 v110, s38, v110
    v_max_f32 v111, s38, v111
    v_pk_add_f32 v[104:105], v[112:113], v[104:105]
    v_pk_add_f32 v[106:107], v[114:115], v[106:107]
    v_pk_add_f32 v[108:109], v[116:117], v[108:109]
    v_pk_add_f32 v[110:111], v[118:119], v[110:111]
    v_cvt_pk_bf16_f32 v152, v104, v105
    v_cvt_pk_bf16_f32 v153, v106, v107
    v_cvt_pk_bf16_f32 v154, v108, v109
    v_cvt_pk_bf16_f32 v155, v110, v111
    s_waitcnt lgkmcnt(2)
    v_lshlrev_b32 v104, 16, v156
    v_and_b32 v105, s39, v156
    v_lshlrev_b32 v106, 16, v157
    v_and_b32 v107, s39, v157
    v_lshlrev_b32 v108, 16, v158
    v_and_b32 v109, s39, v158
    v_lshlrev_b32 v110, 16, v159
    v_and_b32_e64 v111, s39, v159
    v_pk_mul_f32 v[112:113], v[104:105], s[40:41]
    v_pk_mul_f32 v[114:115], v[106:107], s[40:41]
    v_pk_mul_f32 v[116:117], v[108:109], s[40:41]
    v_pk_mul_f32 v[118:119], v[110:111], s[40:41]
    v_exp_f32 v112, v112 clamp
    v_exp_f32 v113, v113 clamp
    v_exp_f32 v114, v114 clamp
    v_exp_f32 v115, v115 clamp
    v_exp_f32 v116, v116 clamp
    v_exp_f32 v117, v117 clamp
    v_exp_f32 v118, v118 clamp
    v_exp_f32 v119, v119 clamp
    v_max_f32 v104, s38, v104
    v_max_f32 v105, s38, v105
    v_max_f32 v106, s38, v106
    v_max_f32 v107, s38, v107
    v_max_f32 v108, s38, v108
    v_max_f32 v109, s38, v109
    v_max_f32 v110, s38, v110
    v_max_f32 v111, s38, v111
    v_pk_add_f32 v[104:105], v[112:113], v[104:105]
    v_pk_add_f32 v[106:107], v[114:115], v[106:107]
    v_pk_add_f32 v[108:109], v[116:117], v[108:109]
    v_pk_add_f32 v[110:111], v[118:119], v[110:111]
    v_cvt_pk_bf16_f32 v156, v104, v105
    v_cvt_pk_bf16_f32 v157, v106, v107
    v_cvt_pk_bf16_f32 v158, v108, v109
    v_cvt_pk_bf16_f32 v159, v110, v111
    s_waitcnt vmcnt(10)
L_hsE:
    v_cmp_ne_u64 vcc, s[0:1], v[120:121]
    s_cbranch_vccnz L_hrE
L_goE:
    buffer_load_dwordx4 v[168:171], v9, s[28:31], s60 offen offset:0 sc1
    buffer_load_dwordx4 v[172:175], v9, s[28:31], s64 offen offset:0 sc1
    buffer_load_dwordx4 v[178:181], v9, s[28:31], s60 offen offset:1024 sc1
    buffer_load_dwordx4 v[182:185], v9, s[28:31], s64 offen offset:1024 sc1
    s_barrier
    buffer_load_dwordx4 v[188:191], v9, s[28:31], s61 offen offset:0 sc1
    buffer_load_dwordx4 v[192:195], v9, s[28:31], s65 offen offset:0 sc1
    buffer_load_dwordx4 v[198:201], v9, s[28:31], s61 offen offset:1024 sc1
    buffer_load_dwordx4 v[202:205], v9, s[28:31], s65 offen offset:1024 sc1
    buffer_load_dwordx4 v[208:211], v9, s[28:31], s62 offen offset:0 sc1
    buffer_load_dwordx4 v[212:215], v9, s[28:31], s66 offen offset:0 sc1
    buffer_load_dwordx4 v[218:221], v9, s[28:31], s62 offen offset:1024 sc1
    buffer_load_dwordx4 v[222:225], v9, s[28:31], s66 offen offset:1024 sc1
    buffer_load_dwordx4 v[228:231], v9, s[28:31], s63 offen offset:0 sc1
    buffer_load_dwordx4 v[232:235], v9, s[28:31], s67 offen offset:0 sc1
    buffer_load_dwordx4 v[238:241], v9, s[28:31], s63 offen offset:1024 sc1
    buffer_load_dwordx4 v[242:245], v9, s[28:31], s67 offen offset:1024 sc1
    buffer_load_dwordx4 v[248:251], v19, s[28:31], s5 offen offset:0 sc1
    buffer_load_dwordx4 v[252:255], v19, s[28:31], s5 offen offset:1024 sc1
    s_waitcnt lgkmcnt(1)
    v_lshlrev_b32 v104, 16, v160
    v_and_b32 v105, s39, v160
    v_lshlrev_b32 v106, 16, v161
    v_and_b32 v107, s39, v161
    v_lshlrev_b32 v108, 16, v162
    v_and_b32 v109, s39, v162
    v_lshlrev_b32 v110, 16, v163
    v_and_b32_e64 v111, s39, v163
    v_pk_mul_f32 v[112:113], v[104:105], s[40:41]
    v_pk_mul_f32 v[114:115], v[106:107], s[40:41]
    v_pk_mul_f32 v[116:117], v[108:109], s[40:41]
    v_pk_mul_f32 v[118:119], v[110:111], s[40:41]
    v_exp_f32 v112, v112 clamp
    v_exp_f32 v113, v113 clamp
    v_exp_f32 v114, v114 clamp
    v_exp_f32 v115, v115 clamp
    v_exp_f32 v116, v116 clamp
    v_exp_f32 v117, v117 clamp
    v_exp_f32 v118, v118 clamp
    v_exp_f32 v119, v119 clamp
    v_max_f32 v104, s38, v104
    v_max_f32 v105, s38, v105
    v_max_f32 v106, s38, v106
    v_max_f32 v107, s38, v107
    v_max_f32 v108, s38, v108
    v_max_f32 v109, s38, v109
    v_max_f32 v110, s38, v110
    v_max_f32 v111, s38, v111
    v_pk_add_f32 v[104:105], v[112:113], v[104:105]
    v_pk_add_f32 v[106:107], v[114:115], v[106:107]
    v_pk_add_f32 v[108:109], v[116:117], v[108:109]
    v_pk_add_f32 v[110:111], v[118:119], v[110:111]
    v_cvt_pk_bf16_f32 v160, v104, v105
    v_cvt_pk_bf16_f32 v161, v106, v107
    v_cvt_pk_bf16_f32 v162, v108, v109
    v_cvt_pk_bf16_f32 v163, v110, v111
    s_waitcnt lgkmcnt(0)
    v_lshlrev_b32 v104, 16, v164
    v_and_b32 v105, s39, v164
    v_lshlrev_b32 v106, 16, v165
    v_and_b32 v107, s39, v165
    v_lshlrev_b32 v108, 16, v166
    v_and_b32 v109, s39, v166
    v_lshlrev_b32 v110, 16, v167
    v_and_b32_e64 v111, s39, v167
    v_pk_mul_f32 v[112:113], v[104:105], s[40:41]
    v_pk_mul_f32 v[114:115], v[106:107], s[40:41]
    v_pk_mul_f32 v[116:117], v[108:109], s[40:41]
    v_pk_mul_f32 v[118:119], v[110:111], s[40:41]
    v_exp_f32 v112, v112 clamp
    v_exp_f32 v113, v113 clamp
    v_exp_f32 v114, v114 clamp
    v_exp_f32 v115, v115 clamp
    v_exp_f32 v116, v116 clamp
    v_exp_f32 v117, v117 clamp
    v_exp_f32 v118, v118 clamp
    v_exp_f32 v119, v119 clamp
    v_max_f32 v104, s38, v104
    v_max_f32 v105, s38, v105
    v_max_f32 v106, s38, v106
    v_max_f32 v107, s38, v107
    v_max_f32 v108, s38, v108
    v_max_f32 v109, s38, v109
    v_max_f32 v110, s38, v110
    v_max_f32 v111, s38, v111
    v_pk_add_f32 v[104:105], v[112:113], v[104:105]
    v_pk_add_f32 v[106:107], v[114:115], v[106:107]
    v_pk_add_f32 v[108:109], v[116:117], v[108:109]
    v_pk_add_f32 v[110:111], v[118:119], v[110:111]
    v_cvt_pk_bf16_f32 v164, v104, v105
    v_cvt_pk_bf16_f32 v165, v106, v107
    v_cvt_pk_bf16_f32 v166, v108, v109
    v_cvt_pk_bf16_f32 v167, v110, v111
L_gat:
    v_mov_b32 v25, 0
    v_mov_b32 v26, 0
    s_waitcnt vmcnt(14)
    v_mov_b32 v176, v168
    v_mov_b32 v177, v169
    v_mov_b32 v186, v178
    v_mov_b32_e64 v187, v179
    v_max3_u32 v25, v168, v170, v25
    v_max3_u32 v26, v172, v174, v26
    v_max3_u32 v25, v178, v180, v25
    v_max3_u32 v26, v182, v184, v26
    v_mfma_f32_16x16x32_bf16 v[32:35], v[124:127], v[174:177], 0
    v_mfma_f32_16x16x32_bf16 v[36:39], v[124:127], v[184:187], 0
    v_mfma_f32_16x16x32_bf16 v[40:43], v[124:127], v[170:173], 0
    v_mfma_f32_16x16x32_bf16 v[44:47], v[124:127], v[180:183], 0
    s_waitcnt vmcnt(10)
    v_mov_b32 v196, v188
    v_mov_b32 v197, v189
    v_mov_b32 v206, v198
    v_mov_b32_e64 v207, v199
    v_max3_u32 v25, v188, v190, v25
    v_max3_u32 v26, v192, v194, v26
    v_max3_u32 v25, v198, v200, v25
    v_max3_u32 v26, v202, v204, v26
    v_mfma_f32_16x16x32_bf16 v[48:51], v[124:127], v[194:197], 0
    v_mfma_f32_16x16x32_bf16 v[52:55], v[124:127], v[204:207], 0
    v_mfma_f32_16x16x32_bf16 v[56:59], v[124:127], v[190:193], 0
    v_mfma_f32_16x16x32_bf16 v[60:63], v[124:127], v[200:203], 0
    v_cvt_pk_bf16_f32 v96, v32, v33
    v_cvt_pk_bf16_f32 v97, v34, v35
    v_cvt_pk_bf16_f32 v98, v36, v37
    v_cvt_pk_bf16_f32 v99, v38, v39
    ds_write_b128 v20, v[96:99] offset:0
    v_cvt_pk_bf16_f32 v100, v40, v41
    v_cvt_pk_bf16_f32 v101, v42, v43
    v_cvt_pk_bf16_f32 v102, v44, v45
    v_cvt_pk_bf16_f32 v103, v46, v47
    ds_write_b128 v20, v[100:103] offset:64
    s_waitcnt vmcnt(6)
    v_mov_b32 v216, v208
    v_mov_b32 v217, v209
    v_mov_b32 v226, v218
    v_mov_b32_e64 v227, v219
    v_max3_u32 v25, v208, v210, v25
    v_max3_u32 v26, v212, v214, v26
    v_max3_u32 v25, v218, v220, v25
    v_max3_u32 v26, v222, v224, v26
    v_mfma_f32_16x16x32_bf16 v[64:67], v[124:127], v[214:217], 0
    v_mfma_f32_16x16x32_bf16 v[68:71], v[124:127], v[224:227], 0
    v_mfma_f32_16x16x32_bf16 v[72:75], v[124:127], v[210:213], 0
    v_mfma_f32_16x16x32_bf16 v[76:79], v[124:127], v[220:223], 0
    v_cvt_pk_bf16_f32 v104, v48, v49
    v_cvt_pk_bf16_f32 v105, v50, v51
    v_cvt_pk_bf16_f32 v106, v52, v53
    v_cvt_pk_bf16_f32 v107, v54, v55
    ds_write_b128 v20, v[104:107] offset:128
    v_cvt_pk_bf16_f32 v108, v56, v57
    v_cvt_pk_bf16_f32 v109, v58, v59
    v_cvt_pk_bf16_f32 v110, v60, v61
    v_cvt_pk_bf16_f32 v111, v62, v63
    ds_write_b128 v20, v[108:111] offset:192
    v_cvt_pk_bf16_f32 v96, v64, v65
    v_cvt_pk_bf16_f32 v97, v66, v67
    v_cvt_pk_bf16_f32 v98, v68, v69
    v_cvt_pk_bf16_f32 v99, v70, v71
    ds_write_b128 v20, v[96:99] offset:4224
    v_cvt_pk_bf16_f32 v100, v72, v73
    v_cvt_pk_bf16_f32 v101, v74, v75
    v_cvt_pk_bf16_f32 v102, v76, v77
    v_cvt_pk_bf16_f32 v103, v78, v79
    ds_write_b128 v20, v[100:103] offset:4288
    s_waitcnt vmcnt(2)
    v_mov_b32 v236, v228
    v_mov_b32 v237, v229
    v_mov_b32 v246, v238
    v_mov_b32_e64 v247, v239
    v_max3_u32 v25, v228, v230, v25
    v_max3_u32 v26, v232, v234, v26
    v_mfma_f32_16x16x32_bf16 v[80:83], v[124:127], v[234:237], 0
    v_mfma_f32_16x16x32_bf16 v[84:87], v[124:127], v[244:247], 0
    v_mfma_f32_16x16x32_bf16 v[88:91], v[124:127], v[230:233], 0
    v_mfma_f32_16x16x32_bf16 v[92:95], v[124:127], v[240:243], 0
    v_max3_u32 v25, v238, v240, v25
    v_max3_u32 v26, v242, v244, v26
    s_waitcnt vmcnt(0)
    s_mov_b64 exec, 0xff
    v_max3_u32 v25, v248, v250, v25
    v_max3_u32 v26, v252, v254, v26
    v_add_f32 v248, v248, v252
    v_add_f32 v249, v249, v253
    v_add_f32 v250, v250, v254
    v_add_f32_e64 v251, v251, v255
    v_cvt_pk_bf16_f32 v252, v248, v249
    v_cvt_pk_bf16_f32 v253, v250, v251
    ds_write_b64 v21, v[252:253]
    s_mov_b64 exec, -1
    v_max_u32_e64 v25, v25, v26
    v_cmp_eq_u32 vcc, -1, v25
    v_cvt_pk_bf16_f32 v104, v80, v81
    v_cvt_pk_bf16_f32 v105, v82, v83
    v_cvt_pk_bf16_f32 v106, v84, v85
    v_cvt_pk_bf16_f32 v107, v86, v87
    ds_write_b128 v20, v[104:107] offset:4352
    v_cvt_pk_bf16_f32 v108, v88, v89
    v_cvt_pk_bf16_f32 v109, v90, v91
    v_cvt_pk_bf16_f32 v110, v92, v93
    v_cvt_pk_bf16_f32 v111, v94, v95
    ds_write_b128 v20, v[108:111] offset:4416
    s_cbranch_vccnz L_retry
    s_waitcnt lgkmcnt(0)
    s_barrier
L_mm:
    ds_read_b128 v[96:99], v23 offset:0
    ds_read_b128 v[100:103], v23 offset:64
    ds_read_b128 v[104:107], v23 offset:128
    ds_read_b128 v[108:111], v23 offset:192
    ds_read_b128 v[168:171], v22 offset:0
    ds_read_b128 v[172:175], v22 offset:8448
    ds_read_b128 v[176:179], v22 offset:16896
    ds_read_b128 v[180:183], v22 offset:25344
    s_waitcnt lgkmcnt(4)
    v_mfma_f32_16x16x32_bf16 v[112:115], v[136:139], v[96:99], 0
    v_mfma_f32_16x16x32_bf16 v[116:119], v[152:155], v[96:99], 0
    v_mfma_f32_16x16x32_bf16 v[112:115], v[140:143], v[100:103], v[112:115]
    v_mfma_f32_16x16x32_bf16 v[116:119], v[156:159], v[100:103], v[116:119]
    v_mfma_f32_16x16x32_bf16 v[112:115], v[144:147], v[104:107], v[112:115]
    v_mfma_f32_16x16x32_bf16 v[116:119], v[160:163], v[104:107], v[116:119]
    v_mfma_f32_16x16x32_bf16 v[112:115], v[148:151], v[108:111], v[112:115]
    v_mfma_f32_16x16x32_bf16 v[116:119], v[164:167], v[108:111], v[116:119]
    ds_read_b128 v[184:187], v22 offset:1056
    ds_read_b128 v[188:191], v22 offset:9504
    ds_read_b128 v[192:195], v22 offset:17952
    ds_read_b128 v[196:199], v22 offset:26400
    s_waitcnt lgkmcnt(4)
    v_mfma_f32_16x16x32_bf16 v[32:35], v[136:139], v[168:171], 0
    v_mfma_f32_16x16x32_bf16 v[64:67], v[152:155], v[168:171], 0
    v_mfma_f32_16x16x32_bf16 v[32:35], v[140:143], v[172:175], v[32:35]
    v_mfma_f32_16x16x32_bf16 v[64:67], v[156:159], v[172:175], v[64:67]
    v_mfma_f32_16x16x32_bf16 v[32:35], v[144:147], v[176:179], v[32:35]
    v_mfma_f32_16x16x32_bf16 v[64:67], v[160:163], v[176:179], v[64:67]
    v_mfma_f32_16x16x32_bf16 v[32:35], v[148:151], v[180:183], v[32:35]
    v_add_f32 v112, s38, v112
    v_add_f32_e64 v113, s38, v113
    v_mfma_f32_16x16x32_bf16 v[64:67], v[164:167], v[180:183], v[64:67]
    v_add_f32 v114, s38, v114
    v_add_f32 v115, s38, v115
    ds_read_b128 v[168:171], v22 offset:2112
    ds_read_b128 v[172:175], v22 offset:10560
    ds_read_b128 v[176:179], v22 offset:19008
    ds_read_b128 v[180:183], v22 offset:27456
    s_waitcnt lgkmcnt(4)
    v_mfma_f32_16x16x32_bf16 v[36:39], v[136:139], v[184:187], 0
    v_add_f32 v116, s38, v116
    v_add_f32_e64 v117, s38, v117
    v_mfma_f32_16x16x32_bf16 v[68:71], v[152:155], v[184:187], 0
    v_add_f32 v118, s38, v118
    v_add_f32 v119, s38, v119
    v_mfma_f32_16x16x32_bf16 v[36:39], v[140:143], v[188:191], v[36:39]
    v_rcp_f32_e64 v112, v112
    v_mfma_f32_16x16x32_bf16 v[68:71], v[156:159], v[188:191], v[68:71]
    v_rcp_f32_e64 v113, v113
    v_mfma_f32_16x16x32_bf16 v[36:39], v[144:147], v[192:195], v[36:39]
    v_rcp_f32_e64 v114, v114
    v_mfma_f32_16x16x32_bf16 v[68:71], v[160:163], v[192:195], v[68:71]
    v_rcp_f32_e64 v115, v115
    v_mfma_f32_16x16x32_bf16 v[36:39], v[148:151], v[196:199], v[36:39]
    v_rcp_f32_e64 v116, v116
    v_mfma_f32_16x16x32_bf16 v[68:71], v[164:167], v[196:199], v[68:71]
    v_rcp_f32_e64 v117, v117
    ds_read_b128 v[184:187], v22 offset:3168
    ds_read_b128 v[188:191], v22 offset:11616
    ds_read_b128 v[192:195], v22 offset:20064
    ds_read_b128 v[196:199], v22 offset:28512
    s_waitcnt lgkmcnt(4)
    v_mfma_f32_16x16x32_bf16 v[40:43], v[136:139], v[168:171], 0
    v_rcp_f32 v118, v118
    v_mfma_f32_16x16x32_bf16 v[72:75], v[152:155], v[168:171], 0
    v_rcp_f32_e64 v119, v119
    v_mfma_f32_16x16x32_bf16 v[40:43], v[140:143], v[172:175], v[40:43]
    v_mul_f32 v32, v32, v112
    v_mul_f32 v33, v33, v113
    v_mfma_f32_16x16x32_bf16 v[72:75], v[156:159], v[172:175], v[72:75]
    v_mul_f32 v34, v34, v114
    v_mul_f32 v35, v35, v115
    v_mfma_f32_16x16x32_bf16 v[40:43], v[144:147], v[176:179], v[40:43]
    v_mul_f32 v64, v64, v116
    v_mul_f32 v65, v65, v117
    v_mfma_f32_16x16x32_bf16 v[72:75], v[160:163], v[176:179], v[72:75]
    v_mul_f32 v66, v66, v118
    v_mul_f32 v67, v67, v119
    v_mfma_f32_16x16x32_bf16 v[40:43], v[148:151], v[180:183], v[40:43]
    v_mul_f32 v36, v36, v112
    v_mul_f32 v37, v37, v113
    v_mfma_f32_16x16x32_bf16 v[72:75], v[164:167], v[180:183], v[72:75]
    v_mul_f32 v38, v38, v114
    v_mul_f32 v39, v39, v115
    ds_read_b128 v[168:171], v22 offset:4224
    ds_read_b128 v[172:175], v22 offset:12672
    ds_read_b128 v[176:179], v22 offset:21120
    ds_read_b128 v[180:183], v22 offset:29568
    s_waitcnt lgkmcnt(4)
    v_mfma_f32_16x16x32_bf16 v[44:47], v[136:139], v[184:187], 0
    v_mul_f32 v68, v68, v116
    v_mul_f32_e64 v69, v69, v117
    v_mfma_f32_16x16x32_bf16 v[76:79], v[152:155], v[184:187], 0
    v_mul_f32 v70, v70, v118
    v_mul_f32 v71, v71, v119
    v_mfma_f32_16x16x32_bf16 v[44:47], v[140:143], v[188:191], v[44:47]
    v_cvt_pk_bf16_f32 v200, v32, v36
    v_cvt_pk_bf16_f32 v204, v33, v37
    v_mfma_f32_16x16x32_bf16 v[76:79], v[156:159], v[188:191], v[76:79]
    v_cvt_pk_bf16_f32 v208, v34, v38
    v_cvt_pk_bf16_f32 v212, v35, v39
    v_mfma_f32_16x16x32_bf16 v[44:47], v[144:147], v[192:195], v[44:47]
    v_cvt_pk_bf16_f32 v216, v64, v68
    v_cvt_pk_bf16_f32 v220, v65, v69
    v_mfma_f32_16x16x32_bf16 v[76:79], v[160:163], v[192:195], v[76:79]
    v_cvt_pk_bf16_f32 v224, v66, v70
    v_cvt_pk_bf16_f32 v228, v67, v71
    v_mfma_f32_16x16x32_bf16 v[44:47], v[148:151], v[196:199], v[44:47]
    v_mul_f32 v40, v40, v112
    v_mul_f32 v41, v41, v113
    v_mfma_f32_16x16x32_bf16 v[76:79], v[164:167], v[196:199], v[76:79]
    v_mul_f32 v42, v42, v114
    v_mul_f32 v43, v43, v115
    ds_read_b128 v[184:187], v22 offset:5280
    ds_read_b128 v[188:191], v22 offset:13728
    ds_read_b128 v[192:195], v22 offset:22176
    ds_read_b128 v[196:199], v22 offset:30624
    s_waitcnt lgkmcnt(4)
    v_mfma_f32_16x16x32_bf16 v[48:51], v[136:139], v[168:171], 0
    v_mul_f32 v72, v72, v116
    v_mul_f32_e64 v73, v73, v117
    v_mfma_f32_16x16x32_bf16 v[80:83], v[152:155], v[168:171], 0
    v_mul_f32 v74, v74, v118
    v_mul_f32 v75, v75, v119
    v_mfma_f32_16x16x32_bf16 v[48:51], v[140:143], v[172:175], v[48:51]
    v_mfma_f32_16x16x32_bf16 v[80:83], v[156:159], v[172:175], v[80:83]
    v_mfma_f32_16x16x32_bf16 v[48:51], v[144:147], v[176:179], v[48:51]
    v_mul_f32 v44, v44, v112
    v_mul_f32 v45, v45, v113
    v_mfma_f32_16x16x32_bf16 v[80:83], v[160:163], v[176:179], v[80:83]
    v_mul_f32 v46, v46, v114
    v_mul_f32 v47, v47, v115
    v_mfma_f32_16x16x32_bf16 v[48:51], v[148:151], v[180:183], v[48:51]
    v_mul_f32 v76, v76, v116
    v_mul_f32 v77, v77, v117
    v_mfma_f32_16x16x32_bf16 v[80:83], v[164:167], v[180:183], v[80:83]
    v_mul_f32 v78, v78, v118
    v_mul_f32 v79, v79, v119
    ds_read_b128 v[168:171], v22 offset:6336
    ds_read_b128 v[172:175], v22 offset:14784
    ds_read_b128 v[176:179], v22 offset:23232
    ds_read_b128 v[180:183], v22 offset:31680
    s_waitcnt lgkmcnt(4)
    v_mfma_f32_16x16x32_bf16 v[52:55], v[136:139], v[184:187], 0
    v_cvt_pk_bf16_f32 v201, v40, v44
    v_cvt_pk_bf16_f32 v205, v41, v45
    v_mfma_f32_16x16x32_bf16 v[84:87], v[152:155], v[184:187], 0
    v_cvt_pk_bf16_f32 v209, v42, v46
    v_cvt_pk_bf16_f32 v213, v43, v47
    v_mfma_f32_16x16x32_bf16 v[52:55], v[140:143], v[188:191], v[52:55]
    v_cvt_pk_bf16_f32 v217, v72, v76
    v_cvt_pk_bf16_f32 v221, v73, v77
    v_mfma_f32_16x16x32_bf16 v[84:87], v[156:159], v[188:191], v[84:87]
    v_cvt_pk_bf16_f32 v225, v74, v78
    v_cvt_pk_bf16_f32 v229, v75, v79
    v_mfma_f32_16x16x32_bf16 v[52:55], v[144:147], v[192:195], v[52:55]
    v_mul_f32 v48, v48, v112
    v_mul_f32_e64 v49, v49, v113
    buffer_store_dwordx2 v[200:201], v24, s[20:23], s68 offen offset:0 nt
    v_mfma_f32_16x16x32_bf16 v[84:87], v[160:163], v[192:195], v[84:87]
    v_mul_f32 v50, v50, v114
    v_mul_f32 v51, v51, v115
    buffer_store_dwordx2 v[204:205], v24, s[20:23], s68 offen offset:256 nt
    v_mfma_f32_16x16x32_bf16 v[52:55], v[148:151], v[196:199], v[52:55]
    v_mul_f32 v80, v80, v116
    v_mul_f32 v81, v81, v117
    buffer_store_dwordx2 v[208:209], v24, s[20:23], s68 offen offset:512 nt
    v_mfma_f32_16x16x32_bf16 v[84:87], v[164:167], v[196:199], v[84:87]
    v_mul_f32 v82, v82, v118
    v_mul_f32 v83, v83, v119
    buffer_store_dwordx2 v[212:213], v24, s[20:23], s68 offen offset:768 nt
    ds_read_b128 v[184:187], v22 offset:7392
    ds_read_b128 v[188:191], v22 offset:15840
    ds_read_b128 v[192:195], v22 offset:24288
    ds_read_b128 v[196:199], v22 offset:32736
    s_waitcnt lgkmcnt(4)
    v_mfma_f32_16x16x32_bf16 v[56:59], v[136:139], v[168:171], 0
    buffer_store_dwordx2 v[216:217], v24, s[20:23], s69 offen offset:0 nt
    v_mfma_f32_16x16x32_bf16 v[88:91], v[152:155], v[168:171], 0
    buffer_store_dwordx2 v[220:221], v24, s[20:23], s69 offen offset:256 nt
    v_mfma_f32_16x16x32_bf16 v[56:59], v[140:143], v[172:175], v[56:59]
    buffer_store_dwordx2 v[224:225], v24, s[20:23], s69 offen offset:512 nt
    v_mfma_f32_16x16x32_bf16 v[88:91], v[156:159], v[172:175], v[88:91]
    buffer_store_dwordx2 v[228:229], v24, s[20:23], s69 offen offset:768 nt
    v_mfma_f32_16x16x32_bf16 v[56:59], v[144:147], v[176:179], v[56:59]
    v_mul_f32 v52, v52, v112
    v_mul_f32_e64 v53, v53, v113
    v_mfma_f32_16x16x32_bf16 v[88:91], v[160:163], v[176:179], v[88:91]
    v_mul_f32 v54, v54, v114
    v_mul_f32 v55, v55, v115
    v_mfma_f32_16x16x32_bf16 v[56:59], v[148:151], v[180:183], v[56:59]
    v_mul_f32 v84, v84, v116
    v_mul_f32 v85, v85, v117
    v_mfma_f32_16x16x32_bf16 v[88:91], v[164:167], v[180:183], v[88:91]
    v_mul_f32 v86, v86, v118
    v_mul_f32_e64 v87, v87, v119
    s_waitcnt lgkmcnt(0)
    v_mfma_f32_16x16x32_bf16 v[60:63], v[136:139], v[184:187], 0
    v_cvt_pk_bf16_f32 v202, v48, v52
    v_cvt_pk_bf16_f32 v206, v49, v53
    v_mfma_f32_16x16x32_bf16 v[92:95], v[152:155], v[184:187], 0
    v_cvt_pk_bf16_f32 v210, v50, v54
    v_cvt_pk_bf16_f32 v214, v51, v55
    v_mfma_f32_16x16x32_bf16 v[60:63], v[140:143], v[188:191], v[60:63]
    v_cvt_pk_bf16_f32 v218, v80, v84
    v_cvt_pk_bf16_f32 v222, v81, v85
    v_mfma_f32_16x16x32_bf16 v[92:95], v[156:159], v[188:191], v[92:95]
    v_cvt_pk_bf16_f32 v226, v82, v86
    v_cvt_pk_bf16_f32 v230, v83, v87
    v_mfma_f32_16x16x32_bf16 v[60:63], v[144:147], v[192:195], v[60:63]
    v_mul_f32 v56, v56, v112
    v_mul_f32 v57, v57, v113
    v_mfma_f32_16x16x32_bf16 v[92:95], v[160:163], v[192:195], v[92:95]
    v_mul_f32 v58, v58, v114
    v_mul_f32 v59, v59, v115
    v_mfma_f32_16x16x32_bf16 v[60:63], v[148:151], v[196:199], v[60:63]
    v_mul_f32 v88, v88, v116
    v_mul_f32 v89, v89, v117
    v_mfma_f32_16x16x32_bf16 v[92:95], v[164:167], v[196:199], v[92:95]
    v_mul_f32 v90, v90, v118
    v_mul_f32 v91, v91, v119
    s_nop 5
    v_mul_f32 v60, v60, v112
    v_mul_f32 v61, v61, v113
    v_mul_f32 v62, v62, v114
    v_mul_f32_e64 v63, v63, v115
    v_cvt_pk_bf16_f32 v203, v56, v60
    buffer_store_dwordx2 v[202:203], v24, s[20:23], s68 offen offset:128 nt
    v_cvt_pk_bf16_f32 v207, v57, v61
    buffer_store_dwordx2 v[206:207], v24, s[20:23], s68 offen offset:384 nt
    v_cvt_pk_bf16_f32 v211, v58, v62
    buffer_store_dwordx2 v[210:211], v24, s[20:23], s68 offen offset:640 nt
    v_cvt_pk_bf16_f32 v215, v59, v63
    buffer_store_dwordx2 v[214:215], v24, s[20:23], s68 offen offset:896 nt
    v_mul_f32 v92, v92, v116
    v_mul_f32 v93, v93, v117
    v_mul_f32 v94, v94, v118
    v_mul_f32 v95, v95, v119
    v_cvt_pk_bf16_f32 v219, v88, v92
    buffer_store_dwordx2 v[218:219], v24, s[20:23], s69 offen offset:128 nt
    v_cvt_pk_bf16_f32 v223, v89, v93
    buffer_store_dwordx2 v[222:223], v24, s[20:23], s69 offen offset:384 nt
    v_cvt_pk_bf16_f32 v227, v90, v94
    buffer_store_dwordx2 v[226:227], v24, s[20:23], s69 offen offset:640 nt
    v_cvt_pk_bf16_f32 v231, v91, v95
    buffer_store_dwordx2 v[230:231], v24, s[20:23], s69 offen offset:896 nt
L_end:
    s_endpgm
L_retry:
    s_add_u32 s6, s6, 1
    s_cmp_ge_u32 s6, 1048576
    s_cbranch_scc1 L_end
    buffer_load_dwordx4 v[168:171], v9, s[28:31], s60 offen offset:0 sc1
    buffer_load_dwordx4 v[172:175], v9, s[28:31], s64 offen offset:0 sc1
    buffer_load_dwordx4 v[178:181], v9, s[28:31], s60 offen offset:1024 sc1
    buffer_load_dwordx4 v[182:185], v9, s[28:31], s64 offen offset:1024 sc1
    buffer_load_dwordx4 v[188:191], v9, s[28:31], s61 offen offset:0 sc1
    buffer_load_dwordx4 v[192:195], v9, s[28:31], s65 offen offset:0 sc1
    buffer_load_dwordx4 v[198:201], v9, s[28:31], s61 offen offset:1024 sc1
    buffer_load_dwordx4 v[202:205], v9, s[28:31], s65 offen offset:1024 sc1
    buffer_load_dwordx4 v[208:211], v9, s[28:31], s62 offen offset:0 sc1
    buffer_load_dwordx4 v[212:215], v9, s[28:31], s66 offen offset:0 sc1
    buffer_load_dwordx4 v[218:221], v9, s[28:31], s62 offen offset:1024 sc1
    buffer_load_dwordx4 v[222:225], v9, s[28:31], s66 offen offset:1024 sc1
    buffer_load_dwordx4 v[228:231], v9, s[28:31], s63 offen offset:0 sc1
    buffer_load_dwordx4 v[232:235], v9, s[28:31], s67 offen offset:0 sc1
    buffer_load_dwordx4 v[238:241], v9, s[28:31], s63 offen offset:1024 sc1
    buffer_load_dwordx4 v[242:245], v9, s[28:31], s67 offen offset:1024 sc1
    buffer_load_dwordx4 v[248:251], v19, s[28:31], s5 offen offset:0 sc1
    buffer_load_dwordx4 v[252:255], v19, s[28:31], s5 offen offset:1024 sc1
    s_waitcnt vmcnt(0)
    s_branch L_gat
L_hrE:
    v_and_b32 v27, v120, v121
    v_and_b32 v27, 0x80808080, v27
    v_cmp_eq_u32 vcc, 0x80808080, v27
    s_cbranch_vccnz L_glE
    v_cmp_eq_u32 vcc, 0, v1
    v_mov_b32 v25, 0x800000
    v_mov_b32 v26, s3
    v_cndmask_b32 v26, v25, v26, vcc
    buffer_store_byte v131, v26, s[24:27], 0 offen sc1
    s_waitcnt vmcnt(0)
    s_add_u32 s6, s6, 1
    s_cmp_ge_u32 s6, 1048576
    s_cbranch_scc1 L_end
    buffer_load_dwordx2 v[120:121], v123, s[24:27], s7 offen sc1
    s_waitcnt vmcnt(0)
    s_branch L_hsE
L_glE:
    s_add_u32 s36, s43, 0x400000
    s_add_u32 s37, s4, 0x400000
    buffer_store_dwordx4 v[60:63], v9, s[28:31], s36 offen sc1
    buffer_store_dwordx4 v[64:67], v18, s[28:31], s37 offen sc1
    s_waitcnt vmcnt(0)
    s_barrier
    v_or_b32 v131, 64, v131
    v_cmp_eq_u32 vcc, 0, v0
    v_mov_b32 v25, 0x800000
    v_mov_b32_e64 v26, s3
    v_cndmask_b32 v26, v25, v26, vcc
    buffer_store_byte v131, v26, s[24:27], 0 offen sc1
L_g2:
    s_add_u32 s6, s6, 1
    s_cmp_ge_u32 s6, 1048576
    s_cbranch_scc1 L_end
    buffer_load_dwordx2 v[120:121], v123, s[24:27], s7 offen sc1
    s_waitcnt vmcnt(0)
    v_and_b32 v27, v120, v121
    v_and_b32 v27, 0x40404040, v27
    v_cmp_eq_u32 vcc, 0x40404040, v27
    s_cbranch_vccz L_g2
    s_add_u32 s60, s60, 0x400000
    s_add_u32 s61, s61, 0x400000
    s_add_u32 s62, s62, 0x400000
    s_add_u32 s63, s63, 0x400000
    s_add_u32 s64, s64, 0x400000
    s_add_u32 s65, s65, 0x400000
    s_add_u32 s66, s66, 0x400000
    s_add_u32 s67, s67, 0x400000
    s_add_u32 s5, s5, 0x400000
    s_branch L_goE
L_hrL:
    v_and_b32_e64 v27, v120, v121
    v_and_b32 v27, 0x80808080, v27
    v_cmp_eq_u32 vcc, 0x80808080, v27
    s_cbranch_vccnz L_glL
    v_cmp_eq_u32 vcc, 0, v1
    v_mov_b32 v25, 0x800000
    v_mov_b32 v26, s3
    v_cndmask_b32 v26, v25, v26, vcc
    buffer_store_byte v131, v26, s[24:27], 0 offen sc1
    s_waitcnt vmcnt(0)
    s_add_u32 s6, s6, 1
    s_cmp_ge_u32 s6, 1048576
    s_cbranch_scc1 L_end
    buffer_load_dwordx2 v[120:121], v123, s[24:27], s7 offen sc1
    s_waitcnt vmcnt(0)
    s_branch L_hsL
L_glL:
    s_add_u32 s36, s43, 0x400000
    s_add_u32 s37, s4, 0x400000
    buffer_store_dwordx4 v[60:63], v9, s[28:31], s36 offen sc1
    buffer_store_dwordx4 v[64:67], v18, s[28:31], s37 offen sc1
    s_waitcnt vmcnt(0)
    s_barrier
    s_branch L_goL
.section .rodata,"a"
.p2align 6
.amdhsa_kernel standalone__linear_attn_elu__prompt_kernel
  .amdhsa_next_free_vgpr 256
  .amdhsa_next_free_sgpr 102
  .amdhsa_accum_offset 256
  .amdhsa_group_segment_fixed_size 0
  .amdhsa_kernarg_size 48
  .amdhsa_user_sgpr_count 2
  .amdhsa_user_sgpr_kernarg_segment_ptr 1
  .amdhsa_system_sgpr_workgroup_id_x 1
.end_amdhsa_kernel
```
